```python
import torch

def _softmax(x, axis=-1):
    return torch.softmax(x, dim=axis)
def _gelu(x):
    return torch.nn.functional.gelu(x, approximate="tanh")
def _silu(x):
    return torch.nn.functional.silu(x)
def _sigmoid(x):
    return torch.sigmoid(x)
def _layernorm(x, axis=-1, eps=1e-5):
    m = x.mean(dim=axis, keepdim=True)
    v = x.var(dim=axis, keepdim=True, unbiased=False)
    return (x - m) / torch.sqrt(v + eps)
def _scatter_add(tgt, idx, src, axis=0):
    return tgt.clone().index_add_(axis, idx, src)
def _segment_sum(src, seg, n):
    out = torch.zeros((n,) + src.shape[1:], dtype=src.dtype)
    return out.index_add_(0, seg, src)
def _pad(x, pw):
    flat = tuple(v for pair in reversed(pw) for v in pair)
    return torch.nn.functional.pad(x, flat)

kernel_name = 'standalone__mixer_token_mlp__sampling'

def setup_inputs():

    _w = (lambda a: (lambda t: t.to(torch.bfloat16) if t.is_floating_point() else t)(torch.as_tensor(a)))
    B, S, D, F = 32, 32, 576, 4608
    return {
        "x": _w((lambda *s: torch.randn(*s, dtype=torch.bfloat16) * 0.05)(B, S, D)),
        "w1": _w((lambda *s: torch.randn(*s, dtype=torch.bfloat16) * 0.2)(S, F) * (S ** -0.5)),
        "b1": _w((lambda *s: torch.randn(*s, dtype=torch.bfloat16) * 3.2)(F) * 0.02),
        "w2": _w((lambda *s: torch.randn(*s, dtype=torch.bfloat16) * 0.05)(F, S) * (F ** -0.5)),
        "b2": _w((lambda *s: torch.randn(*s, dtype=torch.bfloat16) * 0.1)(S) * 0.02),
    }

def reference(x, w1, b1, w2, b2):
    B, S, D = x.shape
    h = _layernorm(x, axis=-1)
    u = torch.einsum("bsd,sf->bdf", h, w1) + b1
    u = _gelu(u)
    y = torch.einsum("bdf,fs->bds", u, w2) + b2
    return (lambda x, *d: x.permute(*d))(y, 0, 2, 1)
```

```asm
; @launch grid=(256,1,1) block=(512,1,1) lds=163840
.amdgcn_target "amdgcn-amd-amdhsa--gfx950"
.text
.globl standalone__mixer_token_mlp__sampling_kernel
.p2align 8
.type standalone__mixer_token_mlp__sampling_kernel,@function
standalone__mixer_token_mlp__sampling_kernel:
    s_load_dwordx16 s[4:19], s[0:1], 0
    s_cmp_ge_u32 s2, 256
    s_cbranch_scc1 L_END
    v_lshrrev_b32 v252, 6, v0
    v_and_b32 v253, 63, v0
    v_readfirstlane_b32 s44, v252
    v_lshlrev_b32 v0, 4, v253
    v_and_b32 v254, 31, v253
    s_and_b32 s45, s2, 31
    s_lshr_b32 s46, s2, 7
    s_bfe_u32 s47, s2, 0x20005
    s_cmp_lt_u32 s44, 4
    s_cbranch_scc1 L_PL
    s_setprio 3
    v_lshrrev_b32 v15, 4, v253
    v_and_b32 v13, 0xf0, v0
    v_mul_u32_u24 v14, 1152, v15
    s_lshl_b32 s80, s45, 2
    s_add_u32 s80, s80, s44
    v_add_u32_e64 v12, v14, v13
    s_mul_i32 s80, s80, 9216
    s_bitcmp1_b32 s47, 0
    s_cselect_b32 s86, 4608, 0
    s_cselect_b32 s87, 1280, 0
    s_sub_u32 s80, s80, 36864
    s_add_u32 s81, s80, s86
    s_waitcnt lgkmcnt(0)
    s_add_u32 s82, s4, s81
    s_addc_u32 s83, s5, 0
    global_load_dwordx4 v[100:103], v12, s[82:83] offset:0
    global_load_dwordx4 v[104:107], v12, s[82:83] offset:256
    global_load_dwordx4 v[108:111], v12, s[82:83] offset:512
    global_load_dwordx4 v[112:115], v12, s[82:83] offset:768
    v_lshrrev_b32 v252, 1, v13
    v_add_u32_e64 v14, v14, v252
    global_load_dwordx2 v[132:133], v14, s[82:83] offset:1024
    s_cmp_ge_u32 s44, 6
    s_cbranch_scc1 L_nco
    s_bfe_u32 s88, s2, 0x20003
    s_mul_i32 s89, s46, 68
    s_add_u32 s88, s88, s89
    s_mul_i32 s89, s47, 18
    s_add_u32 s88, s88, s89
    s_cmp_ge_u32 s88, 72
    s_cselect_b32 s89, 72, 0
    s_sub_u32 s88, s88, s89
    s_bitcmp1_b32 s44, 0
    s_cselect_b64 s[90:91], s[10:11], s[6:7]
    s_cselect_b32 s89, 12, 7
    s_cselect_b32 s92, 1, 72
    s_lshl_b32 s92, s92, 7
    s_lshl_b32 s88, s88, s89
    v_mul_u32_u24 v252, s92, v254
    v_add_u32_e64 v252, s88, v252
    global_load_dword v248, v252, s[90:91]
L_nco:
    s_xor_b32 s86, s86, 4608
    s_add_u32 s81, s80, s86
    s_add_u32 s84, s4, s81
    s_addc_u32 s85, s5, 0
    s_sub_u32 s86, s44, 4
    s_mul_i32 s86, s86, 2592
    v_mul_u32_u24 v15, 320, v15
    s_xor_b32 s93, s87, 1280
    s_add_u32 s93, s93, s86
    s_add_u32 s87, s87, s86
    v_add_u32 v15, v15, v13
    v_add_u32 v18, s93, v15
    v_add_u32_e64 v15, s87, v15
    s_mul_i32 s88, s46, 576
    s_lshl_b32 s89, s47, 7
    s_add_u32 s89, s89, s88
    s_add_u32 s88, s88, 512
    v_add_u32_e64 v252, s89, v12
    v_and_b32 v255, 0xc0, v13
    v_cmp_gt_u32 vcc, 0x80, v13
    v_sub_u32_e64 v255, v12, v255
    v_add_u32 v255, s88, v255
    v_cndmask_b32 v13, v255, v252, vcc
    global_load_dwordx4 v[136:139], v13, s[82:83]
    s_branch L_PV1
L_PL:
    s_mov_b64 exec, 0
    s_cmp_eq_u32 s44, 0
    s_cbranch_scc1 L_pad1_0
    s_cmp_eq_u32 s44, 1
    s_cbranch_scc1 L_pad1_1
    s_cmp_eq_u32 s44, 2
    s_cbranch_scc1 L_pad1_2
    s_branch L_pad1_3
L_ret1:
    s_mov_b64 exec, -1
    s_mov_b32 s88, 0x10000
    s_mov_b32 s87, 0x3ec00000
    v_lshlrev_b32_e64 v255, 19, v253
    v_add_u32 v100, 0x20008000, v255
    v_add_u32 v101, s88, v100
    v_add_u32 v102, s88, v101
    v_add_u32 v103, s88, v102
    v_add_u32 v104, s88, v103
    v_add_u32 v105, s88, v104
    v_add_u32 v106, s88, v105
    v_add_u32 v107, s88, v106
    v_mul_f32 v100, s87, v100
    v_mul_f32 v101, s87, v101
    v_mul_f32 v102, s87, v102
    v_mul_f32 v103, s87, v103
    v_mul_f32 v104, s87, v104
    v_mul_f32 v105, s87, v105
    v_mul_f32 v106, s87, v106
    v_mul_f32 v107, s87, v107
    s_sub_u32 s89, s44, 15
    s_mul_i32 s89, s89, 0x2000200
    s_mov_b32 s90, 0x8000800
    s_mov_b32 s91, 0x10801080
    s_mov_b32 s93, 0x7800780
    s_lshl_b32 s94, s44, 10
    s_add_u32 s94, s94, 65536
    v_cvt_pk_bf16_f32 v112, v100, v101
    v_cvt_pk_bf16_f32 v113, v102, v103
    v_cvt_pk_bf16_f32 v114, v104, v105
    v_cvt_pk_bf16_f32 v115, v106, v107
    v_add_u32 v12, s94, v0
    v_add_u32 v13, s88, v12
    v_add_u32 v108, s89, v112
    v_add_u32 v109, s89, v113
    v_add_u32 v110, s89, v114
    v_add_u32_e64 v111, s89, v115
    ds_write_b128 v12, v[108:111] offset:0
    s_mov_b32 s26, 0x409d30fc
    s_mov_b32 s66, 0x40361376
    s_mov_b32 s28, 0x3faaaaab
    s_mov_b32 s30, 0x05040100
    s_mov_b32 s31, 0x07060302
    s_mov_b32 s29, s28
    s_mov_b32 s27, s26
    v_add_u32 v112, s90, v108
    v_add_u32 v113, s90, v109
    v_add_u32 v114, s90, v110
    v_add_u32 v115, s90, v111
    ds_write_b128 v12, v[112:115] offset:4096
    s_mov_b32 s67, s66
    s_mov_b32 s3, 0
    v_lshrrev_b32 v255, 4, v253
    v_and_b32 v254, 15, v253
    v_lshlrev_b32_e64 v3, 2, v254
    v_mul_u32_u24 v1, 73728, v255
    v_add_u32 v108, s90, v112
    v_add_u32 v109, s90, v113
    v_add_u32 v110, s90, v114
    v_add_u32 v111, s90, v115
    ds_write_b128 v12, v[108:111] offset:8192
    v_and_b32_e64 v252, 1, v255
    v_lshl_add_u32 v2, v252, 10, v3
    v_and_b32_e64 v252, 32, v253
    v_lshl_add_u32 v2, v252, 1, v2
    v_and_b32_e64 v16, 12, v253
    v_add_lshl_u32 v16, v16, v255, 2
    v_add_u32 v112, s90, v108
    v_add_u32 v113, s90, v109
    v_add_u32 v114, s90, v110
    v_add_u32 v115, s90, v111
    ds_write_b128 v12, v[112:115] offset:12288
    v_mov_b32 v7, 0xdddddddd
    s_mov_b32 s64, 0x3faa2fe7
    s_mov_b32 s65, s64
    v_add_u32 v1, v1, v3
    s_bitcmp1_b32 s44, 1
    s_cselect_b32 s21, 48, 44
    v_add_u32 v108, s90, v112
    v_add_u32 v109, s90, v113
    v_add_u32 v110, s90, v114
    v_add_u32 v111, s90, v115
    ds_write_b128 v12, v[108:111] offset:16384
    s_mov_b32 s24, s44
    s_mov_b32 s81, s44
    s_mul_i32 s25, s47, 18
    s_add_u32 s25, s25, s81
    s_cmp_ge_u32 s25, 72
    s_cselect_b32 s80, 72, 0
    v_add_u32 v112, s90, v108
    v_add_u32 v113, s90, v109
    v_add_u32 v114, s90, v110
    v_add_u32 v115, s90, v111
    ds_write_b128 v12, v[112:115] offset:20480
    s_sub_u32 s25, s25, s80
    s_lshl_b32 s80, s25, 7
    s_lshl_b32 s81, s80, 5
    v_add_u32 v1, s80, v1
    v_add_u32 v2, s81, v2
    v_mov_b32 v6, 0
    v_add_u32 v108, s90, v112
    v_add_u32 v109, s90, v113
    v_add_u32 v110, s90, v114
    v_add_u32 v111, s90, v115
    ds_write_b128 v12, v[108:111] offset:24576
    v_mov_b32 v205, 0
    v_mov_b32 v206, 0
    v_mov_b32 v209, 0
    v_mov_b32 v210, 0
    v_mov_b32 v212, 0
    v_mov_b32 v213, 0
    v_add_u32 v112, s91, v108
    v_add_u32 v113, s91, v109
    v_add_u32 v114, s91, v110
    v_add_u32 v115, s91, v111
    ds_write_b128 v12, v[112:115] offset:32768
    v_mov_b32 v214, 0
    v_mov_b32 v215, 0
    v_mov_b32 v216, 0
    v_mov_b32 v217, 0
    v_mov_b32 v218, 0
    v_mov_b32 v219, 0
    v_add_u32 v108, s90, v112
    v_add_u32 v109, s90, v113
    v_add_u32 v110, s90, v114
    v_add_u32 v111, s90, v115
    ds_write_b128 v12, v[108:111] offset:36864
    v_mov_b32 v204, 0x3ef0
    v_mfma_f32_32x32x8_bf16 v[52:67], v[212:213], v[212:213], 0
    v_mov_b32 v207, v204
    v_lshlrev_b32 v208, 16, v204
    v_lshlrev_b32 v211, 16, v204
    v_and_b32 v252, 3, v253
    v_add_u32 v112, s90, v108
    v_add_u32 v113, s90, v109
    v_add_u32 v114, s90, v110
    v_add_u32 v115, s90, v111
    ds_write_b128 v12, v[112:115] offset:40960
    v_lshrrev_b32_e64 v17, 2, v254
    v_lshl_add_u32 v17, v255, 3, v17
    v_mfma_f32_32x32x8_bf16 v[68:83], v[212:213], v[212:213], 0
    v_mul_u32_u24 v17, 320, v17
    v_lshl_add_u32 v17, v252, 3, v17
    v_lshl_add_u32 v17, v255, 5, v17
    v_add_u32 v108, s90, v112
    v_add_u32 v109, s90, v113
    v_add_u32 v110, s90, v114
    v_add_u32 v111, s90, v115
    ds_write_b128 v12, v[108:111] offset:45056
L_pad1_0:
    s_cbranch_execz L_ret1
    v_add_u32 v146, 0, v17
    v_add_u32 v147, 64, v17
    s_lshl_b32 s81, s44, 13
    v_add_u32_e64 v11, s81, v0
    v_mul_u32_u24 v145, 576, v16
    v_lshl_add_u32 v145, v252, 3, v145
    v_add_u32 v112, s90, v108
    v_add_u32 v113, s90, v109
    v_add_u32 v114, s90, v110
    v_add_u32 v115, s90, v111
    ds_write_b128 v12, v[112:115] offset:49152
    s_waitcnt lgkmcnt(0)
    s_mul_i32 s1, s45, 36864
    s_mul_i32 s81, s46, 576
    s_add_u32 s1, s1, s81
    s_lshl_b32 s81, s47, 3
    s_add_u32 s81, s81, s44
    v_add_u32 v108, s90, v112
    v_add_u32 v109, s90, v113
    v_add_u32 v110, s90, v114
    v_add_u32 v111, s90, v115
    ds_write_b128 v12, v[108:111] offset:53248
    s_lshl_b32 s81, s81, 4
    s_add_u32 s1, s1, s81
    s_and_b32 s81, s44, 1
    s_mul_i32 s81, s81, 1136
    s_add_u32 s1, s1, s81
    s_mov_b32 s32, s8
    v_add_u32 v112, s90, v108
    v_add_u32 v113, s90, v109
    v_add_u32 v114, s90, v110
    v_add_u32_e64 v115, s90, v111
    ds_write_b128 v12, v[112:115] offset:57344
    s_mov_b32 s33, s9
    s_mov_b32 s34, 9216
    s_mov_b32 s35, 0x00020000
    s_mov_b32 s36, s14
    s_mov_b32 s37, s15
    s_mov_b32 s38, 1179648
    v_add_u32 v108, s90, v112
    v_add_u32 v109, s90, v113
    v_add_u32 v110, s90, v114
    v_add_u32_e64 v111, s90, v115
    ds_write_b128 v12, v[108:111] offset:61440
    s_mov_b32 s39, 0x00020000
    s_mov_b32 s40, s18
    s_mov_b32 s41, s19
    s_mov_b32 s42, 1048576
    s_mov_b32 s43, 0x00020000
    s_movk_i32 s80, 9216
    v_add_u32 v112, s93, v108
    v_add_u32 v113, s93, v109
    v_add_u32 v114, s93, v110
    v_add_u32_e64 v115, s93, v111
    ds_write_b128 v13, v[112:115] offset:0
    s_mov_b64 s[48:49], s[6:7]
    s_add_u32 s50, s48, s80
    s_addc_u32 s51, s49, 0
    s_add_u32 s52, s50, s80
    s_addc_u32 s53, s51, 0
    s_add_u32 s54, s52, s80
    v_add_u32 v108, s90, v112
    v_add_u32 v109, s90, v113
    v_add_u32 v110, s90, v114
    v_add_u32 v111, s90, v115
    ds_write_b128 v13, v[108:111] offset:4096
    s_addc_u32 s55, s53, 0
    s_add_u32 s56, s54, s80
    s_addc_u32 s57, s55, 0
    s_add_u32 s58, s56, s80
    s_addc_u32 s59, s57, 0
    s_add_u32 s60, s58, s80
    v_add_u32 v112, s90, v108
    v_add_u32 v113, s90, v109
    v_add_u32 v114, s90, v110
    v_add_u32 v115, s90, v111
    ds_write_b128 v13, v[112:115] offset:8192
    s_addc_u32 s61, s59, 0
    s_add_u32 s62, s60, s80
    s_addc_u32 s63, s61, 0
    s_nop 0
    v_mfma_f32_32x32x8_bf16 v[84:99], v[212:213], v[212:213], 0
    v_mfma_f32_32x32x8_bf16 v[116:131], v[212:213], v[212:213], 0
    v_mfma_f32_32x32x8_bf16 v[220:235], v[212:213], v[212:213], 0
    global_load_dword v148, v1, s[48:49] offset:0
    global_load_dword v156, v1, s[48:49] offset:64
    global_load_dword v149, v1, s[50:51] offset:0
    global_load_dword v157, v1, s[50:51] offset:64
    global_load_dword v150, v1, s[52:53] offset:0
    global_load_dword v158, v1, s[52:53] offset:64
    global_load_dword v151, v1, s[54:55] offset:0
    global_load_dword v159, v1, s[54:55] offset:64
    global_load_dword v152, v1, s[56:57] offset:0
    global_load_dword v160, v1, s[56:57] offset:64
    global_load_dword v153, v1, s[58:59] offset:0
    global_load_dword v161, v1, s[58:59] offset:64
    global_load_dword v154, v1, s[60:61] offset:0
    global_load_dword v162, v1, s[60:61] offset:64
    global_load_dword v155, v1, s[62:63] offset:0
    global_load_dword v163, v1, s[62:63] offset:64
    buffer_load_dword v4, v1, s[32:35], 0 offen offset:0
    buffer_load_dword v5, v1, s[32:35], 0 offen offset:64
    v_add_u32 v108, s90, v112
    v_add_u32 v109, s90, v113
    v_add_u32 v110, s90, v114
    v_add_u32 v111, s90, v115
    ds_write_b128 v13, v[108:111] offset:12288
    v_add_u32 v112, s90, v108
    v_add_u32 v113, s90, v109
    v_add_u32 v114, s90, v110
    v_add_u32 v115, s90, v111
    ds_write_b128 v13, v[112:115] offset:16384
    global_load_dword v180, v2, s[10:11] offset:0
    global_load_dword v181, v2, s[10:11] offset:128
    global_load_dword v182, v2, s[10:11] offset:256
    global_load_dword v183, v2, s[10:11] offset:384
    global_load_dword v184, v2, s[10:11] offset:512
    global_load_dword v185, v2, s[10:11] offset:640
    v_add_u32 v108, s90, v112
    v_add_u32 v109, s90, v113
    v_add_u32 v110, s90, v114
    v_add_u32 v111, s90, v115
    ds_write_b128 v13, v[108:111] offset:20480
    global_load_dword v186, v2, s[10:11] offset:768
    global_load_dword v187, v2, s[10:11] offset:896
    global_load_dword v196, v2, s[10:11] offset:2048
    global_load_dword v197, v2, s[10:11] offset:2176
    global_load_dword v198, v2, s[10:11] offset:2304
    global_load_dword v199, v2, s[10:11] offset:2432
    v_add_u32 v112, s90, v108
    v_add_u32 v113, s90, v109
    v_add_u32 v114, s90, v110
    v_add_u32 v115, s90, v111
    ds_write_b128 v13, v[112:115] offset:24576
    global_load_dword v200, v2, s[10:11] offset:2560
    global_load_dword v201, v2, s[10:11] offset:2688
    global_load_dword v202, v2, s[10:11] offset:2816
    global_load_dword v203, v2, s[10:11] offset:2944
    global_load_dword v20, v16, s[12:13]
    s_cmp_eq_u32 s44, 3
    s_cbranch_scc0 L_sp1
    ds_write_b128 v12, v[212:215] offset:61440
L_sp1:
    s_cmp_eq_u32 s44, 0
    s_cbranch_scc0 L_sp2
    ds_write_b128 v0, v[212:215] offset:64512
    ds_write_b128 v0, v[212:215]
L_sp2:
    s_cmp_eq_u32 s44, 2
    s_cbranch_scc0 L_sp3
    v_lshrrev_b32_e64 v252, 2, v0
    v_add_u32 v252, 0xff00, v252
    v_mov_b32 v254, 0x7fc07fc0
    ds_write_b32 v252, v254 offset:64512
L_sp3:
    s_setprio 2
    s_waitcnt vmcnt(17)
L_JOIN:
    v_perm_b32 v172, v149, v148, s30
    v_perm_b32 v173, v151, v150, s30
    v_perm_b32 v174, v153, v152, s30
    v_perm_b32 v175, v155, v154, s30
    v_perm_b32 v176, v149, v148, s31
    v_perm_b32 v177, v151, v150, s31
    v_perm_b32 v178, v153, v152, s31
    v_perm_b32 v179, v155, v154, s31
    v_mfma_f32_16x16x16_bf16 v[132:135], v[4:5], v[204:205], 0
    v_mfma_f32_16x16x16_bf16 v[136:139], v[4:5], v[208:209], 0
    s_waitcnt lgkmcnt(0)
    s_barrier
    ds_read_b64_tr_b16 v[28:29], v146 offset:1024
    ds_read_b64_tr_b16 v[30:31], v146 offset:2304
    ds_read_b64_tr_b16 v[32:33], v146 offset:1056
    ds_read_b64_tr_b16 v[34:35], v146 offset:2336
    ds_read_b64_tr_b16 v[36:37], v147 offset:1024
    ds_read_b64_tr_b16 v[38:39], v147 offset:2304
    ds_read_b64_tr_b16 v[40:41], v147 offset:1056
    ds_read_b64_tr_b16 v[42:43], v147 offset:2336
    s_cmp_ge_u32 s44, 4
    s_cbranch_scc1 L_V22pre
    ds_read_b64_tr_b16 v[44:45], v17 offset:1152
    ds_read_b64_tr_b16 v[46:47], v17 offset:2432
    ds_read_b64_tr_b16 v[48:49], v17 offset:1184
    ds_read_b64_tr_b16 v[50:51], v17 offset:2464
L_pad1_1:
    s_cbranch_execz L_ret1
    s_waitcnt lgkmcnt(10)
    v_mfma_f32_16x16x32_bf16 v[100:103], v[172:175], v[28:31], v[132:135]
    v_mfma_f32_16x16x32_bf16 v[104:107], v[176:179], v[28:31], v[136:139]
    s_waitcnt lgkmcnt(8)
    v_mfma_f32_16x16x32_bf16 v[108:111], v[172:175], v[32:35], v[132:135]
    v_mfma_f32_16x16x32_bf16 v[112:115], v[176:179], v[32:35], v[136:139]
    s_waitcnt lgkmcnt(0)
.p2align 3
L_L33:
    s_cmp_ge_u32 s25, 68
    s_cselect_b32 s80, -68, 4
    s_add_u32 s25, s25, s80
    s_lshl_b32 s80, s80, 7
    s_lshl_b32 s81, s80, 5
    v_add_u32 v1, s80, v1
    v_add_u32 v2, s81, v2
    s_waitcnt lgkmcnt(14)
    v_smfmac_f32_16x16x64_bf16 v[52:55], v[212:215], v[116:123], v7
    v_lshlrev_b32_sdwa v100, 1, v100 dst_sel:DWORD dst_unused:UNUSED_PAD src0_sel:DWORD src1_sel:WORD_1
    v_smfmac_f32_16x16x64_bf16 v[56:59], v[216:219], v[116:123], v7
    v_lshlrev_b32_sdwa v101, 1, v101 dst_sel:DWORD dst_unused:UNUSED_PAD src0_sel:DWORD src1_sel:WORD_1
    v_smfmac_f32_16x16x64_bf16 v[60:63], v[212:215], v[124:131], v7
    v_lshlrev_b32_sdwa v102, 1, v102 dst_sel:DWORD dst_unused:UNUSED_PAD src0_sel:DWORD src1_sel:WORD_1
    v_smfmac_f32_16x16x64_bf16 v[64:67], v[216:219], v[124:131], v7
    v_lshlrev_b32_sdwa v103, 1, v103 dst_sel:DWORD dst_unused:UNUSED_PAD src0_sel:DWORD src1_sel:WORD_1
    v_lshlrev_b32_sdwa v104, 1, v104 dst_sel:DWORD dst_unused:UNUSED_PAD src0_sel:DWORD src1_sel:WORD_1
    v_lshlrev_b32_sdwa v105, 1, v105 dst_sel:DWORD dst_unused:UNUSED_PAD src0_sel:DWORD src1_sel:WORD_1
    v_lshlrev_b32_sdwa v106, 1, v106 dst_sel:DWORD dst_unused:UNUSED_PAD src0_sel:DWORD src1_sel:WORD_1
    v_lshlrev_b32_sdwa v107, 1, v107 dst_sel:DWORD dst_unused:UNUSED_PAD src0_sel:DWORD src1_sel:WORD_1
    v_perm_b32 v164, v157, v156, s30
    v_perm_b32 v165, v159, v158, s30
    v_perm_b32 v166, v161, v160, s30
    v_perm_b32 v167, v163, v162, s30
    ds_read_u16_d16_hi v100, v100 offset:64512
    ds_read_u16_d16_hi v101, v101 offset:64512
    ds_read_u16_d16_hi v102, v102 offset:64512
    ds_read_u16_d16_hi v103, v103 offset:64512
    ds_read_u16_d16_hi v104, v104 offset:64512
    ds_read_u16_d16_hi v105, v105 offset:64512
    ds_read_u16_d16_hi v106, v106 offset:64512
    ds_read_u16_d16_hi v107, v107 offset:64512
    v_mfma_f32_16x16x32_bf16 v[116:119], v[172:175], v[44:47], v[132:135]
    v_perm_b32 v168, v157, v156, s31
    v_perm_b32 v169, v159, v158, s31
    v_mfma_f32_16x16x32_bf16 v[120:123], v[176:179], v[44:47], v[136:139]
    v_perm_b32 v170, v161, v160, s31
    v_perm_b32 v171, v163, v162, s31
    v_mfma_f32_16x16x32_bf16 v[124:127], v[172:175], v[48:51], v[132:135]
    v_lshlrev_b32_sdwa v108, 1, v108 dst_sel:DWORD dst_unused:UNUSED_PAD src0_sel:DWORD src1_sel:WORD_1
    v_lshlrev_b32_sdwa v109, 1, v109 dst_sel:DWORD dst_unused:UNUSED_PAD src0_sel:DWORD src1_sel:WORD_1
    v_mfma_f32_16x16x32_bf16 v[128:131], v[176:179], v[48:51], v[136:139]
    v_lshlrev_b32_sdwa v110, 1, v110 dst_sel:DWORD dst_unused:UNUSED_PAD src0_sel:DWORD src1_sel:WORD_1
    v_lshlrev_b32_sdwa v111, 1, v111 dst_sel:DWORD dst_unused:UNUSED_PAD src0_sel:DWORD src1_sel:WORD_1
    v_lshlrev_b32_sdwa v112, 1, v112 dst_sel:DWORD dst_unused:UNUSED_PAD src0_sel:DWORD src1_sel:WORD_1
    v_lshlrev_b32_sdwa v113, 1, v113 dst_sel:DWORD dst_unused:UNUSED_PAD src0_sel:DWORD src1_sel:WORD_1
    v_lshlrev_b32_sdwa v114, 1, v114 dst_sel:DWORD dst_unused:UNUSED_PAD src0_sel:DWORD src1_sel:WORD_1
    v_lshlrev_b32_sdwa v115, 1, v115 dst_sel:DWORD dst_unused:UNUSED_PAD src0_sel:DWORD src1_sel:WORD_1
    ds_read_u16_d16_hi v108, v108 offset:64512
    ds_read_u16_d16_hi v109, v109 offset:64512
    ds_read_u16_d16_hi v110, v110 offset:64512
    ds_read_u16_d16_hi v111, v111 offset:64512
    ds_read_u16_d16_hi v112, v112 offset:64512
    ds_read_u16_d16_hi v113, v113 offset:64512
    ds_read_u16_d16_hi v114, v114 offset:64512
    ds_read_u16_d16_hi v115, v115 offset:64512
    global_load_dword v148, v1, s[48:49] offset:0
    global_load_dword v156, v1, s[48:49] offset:64
    global_load_dword v149, v1, s[50:51] offset:0
    global_load_dword v157, v1, s[50:51] offset:64
    global_load_dword v150, v1, s[52:53] offset:0
    global_load_dword v158, v1, s[52:53] offset:64
    global_load_dword v151, v1, s[54:55] offset:0
    global_load_dword v159, v1, s[54:55] offset:64
    global_load_dword v152, v1, s[56:57] offset:0
    global_load_dword v160, v1, s[56:57] offset:64
    global_load_dword v153, v1, s[58:59] offset:0
    global_load_dword v161, v1, s[58:59] offset:64
    global_load_dword v154, v1, s[60:61] offset:0
    global_load_dword v162, v1, s[60:61] offset:64
    global_load_dword v155, v1, s[62:63] offset:0
    global_load_dword v163, v1, s[62:63] offset:64
    s_waitcnt vmcnt(16) lgkmcnt(14)
    s_nop 0
    v_smfmac_f32_16x16x64_bf16 v[68:71], v[212:215], v[220:227], v7
    v_lshlrev_b32_sdwa v116, 1, v116 dst_sel:DWORD dst_unused:UNUSED_PAD src0_sel:DWORD src1_sel:WORD_1
    v_smfmac_f32_16x16x64_bf16 v[72:75], v[216:219], v[220:227], v7
    v_lshlrev_b32_sdwa v117, 1, v117 dst_sel:DWORD dst_unused:UNUSED_PAD src0_sel:DWORD src1_sel:WORD_1
    v_smfmac_f32_16x16x64_bf16 v[76:79], v[212:215], v[228:235], v7
    v_lshlrev_b32_sdwa v118, 1, v118 dst_sel:DWORD dst_unused:UNUSED_PAD src0_sel:DWORD src1_sel:WORD_1
    v_smfmac_f32_16x16x64_bf16 v[80:83], v[216:219], v[228:235], v7
    v_lshlrev_b32_sdwa v119, 1, v119 dst_sel:DWORD dst_unused:UNUSED_PAD src0_sel:DWORD src1_sel:WORD_1
    v_lshlrev_b32_sdwa v120, 1, v120 dst_sel:DWORD dst_unused:UNUSED_PAD src0_sel:DWORD src1_sel:WORD_1
    v_lshlrev_b32_sdwa v121, 1, v121 dst_sel:DWORD dst_unused:UNUSED_PAD src0_sel:DWORD src1_sel:WORD_1
    v_lshlrev_b32_sdwa v122, 1, v122 dst_sel:DWORD dst_unused:UNUSED_PAD src0_sel:DWORD src1_sel:WORD_1
    v_lshlrev_b32_sdwa v123, 1, v123 dst_sel:DWORD dst_unused:UNUSED_PAD src0_sel:DWORD src1_sel:WORD_1
    v_perm_b32 v188, v181, v180, s30
    v_perm_b32 v189, v183, v182, s30
    v_perm_b32 v190, v185, v184, s30
    v_perm_b32 v191, v187, v186, s30
    ds_read_u16_d16_hi v116, v116 offset:64512
    ds_read_u16_d16_hi v117, v117 offset:64512
    ds_read_u16_d16_hi v118, v118 offset:64512
    ds_read_u16_d16_hi v119, v119 offset:64512
    ds_read_u16_d16_hi v120, v120 offset:64512
    ds_read_u16_d16_hi v121, v121 offset:64512
    ds_read_u16_d16_hi v122, v122 offset:64512
    ds_read_u16_d16_hi v123, v123 offset:64512
    v_mfma_f32_16x16x32_bf16 v[220:223], v[172:175], v[36:39], v[132:135]
    v_perm_b32 v192, v181, v180, s31
    v_perm_b32 v193, v183, v182, s31
    v_mfma_f32_16x16x32_bf16 v[224:227], v[176:179], v[36:39], v[136:139]
    v_perm_b32 v194, v185, v184, s31
    v_perm_b32 v195, v187, v186, s31
    v_mfma_f32_16x16x32_bf16 v[228:231], v[172:175], v[40:43], v[132:135]
    v_lshlrev_b32_sdwa v124, 1, v124 dst_sel:DWORD dst_unused:UNUSED_PAD src0_sel:DWORD src1_sel:WORD_1
    v_lshlrev_b32_sdwa v125, 1, v125 dst_sel:DWORD dst_unused:UNUSED_PAD src0_sel:DWORD src1_sel:WORD_1
    v_mfma_f32_16x16x32_bf16 v[232:235], v[176:179], v[40:43], v[136:139]
    v_lshlrev_b32_sdwa v126, 1, v126 dst_sel:DWORD dst_unused:UNUSED_PAD src0_sel:DWORD src1_sel:WORD_1
    v_lshlrev_b32_sdwa v127, 1, v127 dst_sel:DWORD dst_unused:UNUSED_PAD src0_sel:DWORD src1_sel:WORD_1
    v_lshlrev_b32_sdwa v128, 1, v128 dst_sel:DWORD dst_unused:UNUSED_PAD src0_sel:DWORD src1_sel:WORD_1
    v_lshlrev_b32_sdwa v129, 1, v129 dst_sel:DWORD dst_unused:UNUSED_PAD src0_sel:DWORD src1_sel:WORD_1
    v_lshlrev_b32_sdwa v130, 1, v130 dst_sel:DWORD dst_unused:UNUSED_PAD src0_sel:DWORD src1_sel:WORD_1
    v_lshlrev_b32_sdwa v131, 1, v131 dst_sel:DWORD dst_unused:UNUSED_PAD src0_sel:DWORD src1_sel:WORD_1
    ds_read_u16_d16_hi v124, v124 offset:64512
    ds_read_u16_d16_hi v125, v125 offset:64512
    ds_read_u16_d16_hi v126, v126 offset:64512
    ds_read_u16_d16_hi v127, v127 offset:64512
    ds_read_u16_d16_hi v128, v128 offset:64512
    ds_read_u16_d16_hi v129, v129 offset:64512
    ds_read_u16_d16_hi v130, v130 offset:64512
    ds_read_u16_d16_hi v131, v131 offset:64512
    global_load_dword v180, v2, s[10:11] offset:0
    global_load_dword v181, v2, s[10:11] offset:128
    global_load_dword v182, v2, s[10:11] offset:256
    global_load_dword v183, v2, s[10:11] offset:384
    global_load_dword v184, v2, s[10:11] offset:512
    global_load_dword v185, v2, s[10:11] offset:640
    global_load_dword v186, v2, s[10:11] offset:768
    global_load_dword v187, v2, s[10:11] offset:896
    s_waitcnt lgkmcnt(14)
    s_nop 0
    v_mfma_f32_16x16x16_bf16 v[132:135], v[4:5], v[206:207], 0
    v_lshlrev_b32_sdwa v220, 1, v220 dst_sel:DWORD dst_unused:UNUSED_PAD src0_sel:DWORD src1_sel:WORD_1
    v_lshlrev_b32_sdwa v221, 1, v221 dst_sel:DWORD dst_unused:UNUSED_PAD src0_sel:DWORD src1_sel:WORD_1
    v_lshlrev_b32_sdwa v222, 1, v222 dst_sel:DWORD dst_unused:UNUSED_PAD src0_sel:DWORD src1_sel:WORD_1
    v_mfma_f32_16x16x16_bf16 v[136:139], v[4:5], v[210:211], 0
    v_lshlrev_b32_sdwa v223, 1, v223 dst_sel:DWORD dst_unused:UNUSED_PAD src0_sel:DWORD src1_sel:WORD_1
    v_lshlrev_b32_sdwa v224, 1, v224 dst_sel:DWORD dst_unused:UNUSED_PAD src0_sel:DWORD src1_sel:WORD_1
    v_lshlrev_b32_sdwa v225, 1, v225 dst_sel:DWORD dst_unused:UNUSED_PAD src0_sel:DWORD src1_sel:WORD_1
    v_smfmac_f32_16x16x64_bf16 v[52:55], v[188:191], v[100:107], v7
    v_lshlrev_b32_sdwa v226, 1, v226 dst_sel:DWORD dst_unused:UNUSED_PAD src0_sel:DWORD src1_sel:WORD_1
    v_smfmac_f32_16x16x64_bf16 v[56:59], v[192:195], v[100:107], v7
    v_lshlrev_b32_sdwa v227, 1, v227 dst_sel:DWORD dst_unused:UNUSED_PAD src0_sel:DWORD src1_sel:WORD_1
    v_smfmac_f32_16x16x64_bf16 v[60:63], v[188:191], v[108:115], v7
    v_smfmac_f32_16x16x64_bf16 v[64:67], v[192:195], v[108:115], v7
    ds_read_u16_d16_hi v220, v220 offset:64512
    ds_read_u16_d16_hi v221, v221 offset:64512
    ds_read_u16_d16_hi v222, v222 offset:64512
    ds_read_u16_d16_hi v223, v223 offset:64512
    ds_read_u16_d16_hi v224, v224 offset:64512
    ds_read_u16_d16_hi v225, v225 offset:64512
    ds_read_u16_d16_hi v226, v226 offset:64512
    ds_read_u16_d16_hi v227, v227 offset:64512
    v_mfma_f32_16x16x32_bf16 v[100:103], v[164:167], v[44:47], v[132:135]
    v_lshlrev_b32_sdwa v228, 1, v228 dst_sel:DWORD dst_unused:UNUSED_PAD src0_sel:DWORD src1_sel:WORD_1
    v_lshlrev_b32_sdwa v229, 1, v229 dst_sel:DWORD dst_unused:UNUSED_PAD src0_sel:DWORD src1_sel:WORD_1
    v_mfma_f32_16x16x32_bf16 v[104:107], v[168:171], v[44:47], v[136:139]
    v_lshlrev_b32_sdwa v230, 1, v230 dst_sel:DWORD dst_unused:UNUSED_PAD src0_sel:DWORD src1_sel:WORD_1
    v_lshlrev_b32_sdwa v231, 1, v231 dst_sel:DWORD dst_unused:UNUSED_PAD src0_sel:DWORD src1_sel:WORD_1
    v_mfma_f32_16x16x32_bf16 v[108:111], v[164:167], v[48:51], v[132:135]
    v_lshlrev_b32_sdwa v232, 1, v232 dst_sel:DWORD dst_unused:UNUSED_PAD src0_sel:DWORD src1_sel:WORD_1
    v_lshlrev_b32_sdwa v233, 1, v233 dst_sel:DWORD dst_unused:UNUSED_PAD src0_sel:DWORD src1_sel:WORD_1
    v_mfma_f32_16x16x32_bf16 v[112:115], v[168:171], v[48:51], v[136:139]
    v_lshlrev_b32_sdwa v234, 1, v234 dst_sel:DWORD dst_unused:UNUSED_PAD src0_sel:DWORD src1_sel:WORD_1
    v_lshlrev_b32_sdwa v235, 1, v235 dst_sel:DWORD dst_unused:UNUSED_PAD src0_sel:DWORD src1_sel:WORD_1
    ds_read_u16_d16_hi v228, v228 offset:64512
    ds_read_u16_d16_hi v229, v229 offset:64512
    ds_read_u16_d16_hi v230, v230 offset:64512
    ds_read_u16_d16_hi v231, v231 offset:64512
    ds_read_u16_d16_hi v232, v232 offset:64512
    ds_read_u16_d16_hi v233, v233 offset:64512
    ds_read_u16_d16_hi v234, v234 offset:64512
    ds_read_u16_d16_hi v235, v235 offset:64512
    buffer_load_dword v4, v1, s[32:35], 0 offen offset:0
    buffer_load_dword v5, v1, s[32:35], 0 offen offset:64
    s_waitcnt lgkmcnt(14)
    s_nop 0
    v_smfmac_f32_16x16x64_bf16 v[84:87], v[188:191], v[116:123], v7
    v_lshlrev_b32_sdwa v100, 1, v100 dst_sel:DWORD dst_unused:UNUSED_PAD src0_sel:DWORD src1_sel:WORD_1
    v_smfmac_f32_16x16x64_bf16 v[88:91], v[192:195], v[116:123], v7
    v_lshlrev_b32_sdwa v101, 1, v101 dst_sel:DWORD dst_unused:UNUSED_PAD src0_sel:DWORD src1_sel:WORD_1
    v_smfmac_f32_16x16x64_bf16 v[92:95], v[188:191], v[124:131], v7
    v_lshlrev_b32_sdwa v102, 1, v102 dst_sel:DWORD dst_unused:UNUSED_PAD src0_sel:DWORD src1_sel:WORD_1
    v_smfmac_f32_16x16x64_bf16 v[96:99], v[192:195], v[124:131], v7
    v_lshlrev_b32_sdwa v103, 1, v103 dst_sel:DWORD dst_unused:UNUSED_PAD src0_sel:DWORD src1_sel:WORD_1
    v_lshlrev_b32_sdwa v104, 1, v104 dst_sel:DWORD dst_unused:UNUSED_PAD src0_sel:DWORD src1_sel:WORD_1
    v_lshlrev_b32_sdwa v105, 1, v105 dst_sel:DWORD dst_unused:UNUSED_PAD src0_sel:DWORD src1_sel:WORD_1
    v_lshlrev_b32_sdwa v106, 1, v106 dst_sel:DWORD dst_unused:UNUSED_PAD src0_sel:DWORD src1_sel:WORD_1
    v_lshlrev_b32_sdwa v107, 1, v107 dst_sel:DWORD dst_unused:UNUSED_PAD src0_sel:DWORD src1_sel:WORD_1
    v_perm_b32 v212, v197, v196, s30
    v_perm_b32 v213, v199, v198, s30
    v_perm_b32 v214, v201, v200, s30
    v_perm_b32 v215, v203, v202, s30
    ds_read_u16_d16_hi v100, v100 offset:64512
    ds_read_u16_d16_hi v101, v101 offset:64512
    ds_read_u16_d16_hi v102, v102 offset:64512
    ds_read_u16_d16_hi v103, v103 offset:64512
    ds_read_u16_d16_hi v104, v104 offset:64512
    ds_read_u16_d16_hi v105, v105 offset:64512
    ds_read_u16_d16_hi v106, v106 offset:64512
    ds_read_u16_d16_hi v107, v107 offset:64512
    v_mfma_f32_16x16x32_bf16 v[116:119], v[164:167], v[28:31], v[132:135]
    v_perm_b32 v216, v197, v196, s31
    v_perm_b32 v217, v199, v198, s31
    v_mfma_f32_16x16x32_bf16 v[120:123], v[168:171], v[28:31], v[136:139]
    v_perm_b32 v218, v201, v200, s31
    v_perm_b32 v219, v203, v202, s31
    v_mfma_f32_16x16x32_bf16 v[124:127], v[164:167], v[32:35], v[132:135]
    v_lshlrev_b32_sdwa v108, 1, v108 dst_sel:DWORD dst_unused:UNUSED_PAD src0_sel:DWORD src1_sel:WORD_1
    v_lshlrev_b32_sdwa v109, 1, v109 dst_sel:DWORD dst_unused:UNUSED_PAD src0_sel:DWORD src1_sel:WORD_1
    v_mfma_f32_16x16x32_bf16 v[128:131], v[168:171], v[32:35], v[136:139]
    v_lshlrev_b32_sdwa v110, 1, v110 dst_sel:DWORD dst_unused:UNUSED_PAD src0_sel:DWORD src1_sel:WORD_1
    v_lshlrev_b32_sdwa v111, 1, v111 dst_sel:DWORD dst_unused:UNUSED_PAD src0_sel:DWORD src1_sel:WORD_1
    v_lshlrev_b32_sdwa v112, 1, v112 dst_sel:DWORD dst_unused:UNUSED_PAD src0_sel:DWORD src1_sel:WORD_1
    v_lshlrev_b32_sdwa v113, 1, v113 dst_sel:DWORD dst_unused:UNUSED_PAD src0_sel:DWORD src1_sel:WORD_1
    v_lshlrev_b32_sdwa v114, 1, v114 dst_sel:DWORD dst_unused:UNUSED_PAD src0_sel:DWORD src1_sel:WORD_1
    v_lshlrev_b32_sdwa v115, 1, v115 dst_sel:DWORD dst_unused:UNUSED_PAD src0_sel:DWORD src1_sel:WORD_1
    ds_read_u16_d16_hi v108, v108 offset:64512
    ds_read_u16_d16_hi v109, v109 offset:64512
    ds_read_u16_d16_hi v110, v110 offset:64512
    ds_read_u16_d16_hi v111, v111 offset:64512
    ds_read_u16_d16_hi v112, v112 offset:64512
    ds_read_u16_d16_hi v113, v113 offset:64512
    ds_read_u16_d16_hi v114, v114 offset:64512
    ds_read_u16_d16_hi v115, v115 offset:64512
    global_load_dword v196, v2, s[10:11] offset:2048
    global_load_dword v197, v2, s[10:11] offset:2176
    global_load_dword v198, v2, s[10:11] offset:2304
    global_load_dword v199, v2, s[10:11] offset:2432
    global_load_dword v200, v2, s[10:11] offset:2560
    global_load_dword v201, v2, s[10:11] offset:2688
    global_load_dword v202, v2, s[10:11] offset:2816
    global_load_dword v203, v2, s[10:11] offset:2944
    s_waitcnt lgkmcnt(14)
    s_nop 0
    v_smfmac_f32_16x16x64_bf16 v[68:71], v[188:191], v[220:227], v7
    v_lshlrev_b32_sdwa v116, 1, v116 dst_sel:DWORD dst_unused:UNUSED_PAD src0_sel:DWORD src1_sel:WORD_1
    v_smfmac_f32_16x16x64_bf16 v[72:75], v[192:195], v[220:227], v7
    v_lshlrev_b32_sdwa v117, 1, v117 dst_sel:DWORD dst_unused:UNUSED_PAD src0_sel:DWORD src1_sel:WORD_1
    v_smfmac_f32_16x16x64_bf16 v[76:79], v[188:191], v[228:235], v7
    v_lshlrev_b32_sdwa v118, 1, v118 dst_sel:DWORD dst_unused:UNUSED_PAD src0_sel:DWORD src1_sel:WORD_1
    v_smfmac_f32_16x16x64_bf16 v[80:83], v[192:195], v[228:235], v7
    v_lshlrev_b32_sdwa v119, 1, v119 dst_sel:DWORD dst_unused:UNUSED_PAD src0_sel:DWORD src1_sel:WORD_1
    v_lshlrev_b32_sdwa v120, 1, v120 dst_sel:DWORD dst_unused:UNUSED_PAD src0_sel:DWORD src1_sel:WORD_1
    v_lshlrev_b32_sdwa v121, 1, v121 dst_sel:DWORD dst_unused:UNUSED_PAD src0_sel:DWORD src1_sel:WORD_1
    v_lshlrev_b32_sdwa v122, 1, v122 dst_sel:DWORD dst_unused:UNUSED_PAD src0_sel:DWORD src1_sel:WORD_1
    v_lshlrev_b32_sdwa v123, 1, v123 dst_sel:DWORD dst_unused:UNUSED_PAD src0_sel:DWORD src1_sel:WORD_1
    ds_read_u16_d16_hi v116, v116 offset:64512
    ds_read_u16_d16_hi v117, v117 offset:64512
    ds_read_u16_d16_hi v118, v118 offset:64512
    ds_read_u16_d16_hi v119, v119 offset:64512
    ds_read_u16_d16_hi v120, v120 offset:64512
    ds_read_u16_d16_hi v121, v121 offset:64512
    ds_read_u16_d16_hi v122, v122 offset:64512
    ds_read_u16_d16_hi v123, v123 offset:64512
    v_mfma_f32_16x16x32_bf16 v[220:223], v[164:167], v[36:39], v[132:135]
    v_lshlrev_b32_sdwa v124, 1, v124 dst_sel:DWORD dst_unused:UNUSED_PAD src0_sel:DWORD src1_sel:WORD_1
    v_lshlrev_b32_sdwa v125, 1, v125 dst_sel:DWORD dst_unused:UNUSED_PAD src0_sel:DWORD src1_sel:WORD_1
    v_mfma_f32_16x16x32_bf16 v[224:227], v[168:171], v[36:39], v[136:139]
    v_lshlrev_b32_sdwa v126, 1, v126 dst_sel:DWORD dst_unused:UNUSED_PAD src0_sel:DWORD src1_sel:WORD_1
    v_lshlrev_b32_sdwa v127, 1, v127 dst_sel:DWORD dst_unused:UNUSED_PAD src0_sel:DWORD src1_sel:WORD_1
    v_mfma_f32_16x16x32_bf16 v[228:231], v[164:167], v[40:43], v[132:135]
    v_lshlrev_b32_sdwa v128, 1, v128 dst_sel:DWORD dst_unused:UNUSED_PAD src0_sel:DWORD src1_sel:WORD_1
    v_lshlrev_b32_sdwa v129, 1, v129 dst_sel:DWORD dst_unused:UNUSED_PAD src0_sel:DWORD src1_sel:WORD_1
    v_mfma_f32_16x16x32_bf16 v[232:235], v[168:171], v[40:43], v[136:139]
    v_lshlrev_b32_sdwa v130, 1, v130 dst_sel:DWORD dst_unused:UNUSED_PAD src0_sel:DWORD src1_sel:WORD_1
    v_lshlrev_b32_sdwa v131, 1, v131 dst_sel:DWORD dst_unused:UNUSED_PAD src0_sel:DWORD src1_sel:WORD_1
    ds_read_u16_d16_hi v124, v124 offset:64512
    ds_read_u16_d16_hi v125, v125 offset:64512
    ds_read_u16_d16_hi v126, v126 offset:64512
    ds_read_u16_d16_hi v127, v127 offset:64512
    ds_read_u16_d16_hi v128, v128 offset:64512
    ds_read_u16_d16_hi v129, v129 offset:64512
    ds_read_u16_d16_hi v130, v130 offset:64512
    ds_read_u16_d16_hi v131, v131 offset:64512
    s_waitcnt vmcnt(8) lgkmcnt(14)
    s_nop 0
    v_mfma_f32_16x16x16_bf16 v[132:135], v[4:5], v[204:205], 0
    v_lshlrev_b32_sdwa v220, 1, v220 dst_sel:DWORD dst_unused:UNUSED_PAD src0_sel:DWORD src1_sel:WORD_1
    v_lshlrev_b32_sdwa v221, 1, v221 dst_sel:DWORD dst_unused:UNUSED_PAD src0_sel:DWORD src1_sel:WORD_1
    v_lshlrev_b32_sdwa v222, 1, v222 dst_sel:DWORD dst_unused:UNUSED_PAD src0_sel:DWORD src1_sel:WORD_1
    v_mfma_f32_16x16x16_bf16 v[136:139], v[4:5], v[208:209], 0
    v_lshlrev_b32_sdwa v223, 1, v223 dst_sel:DWORD dst_unused:UNUSED_PAD src0_sel:DWORD src1_sel:WORD_1
    v_lshlrev_b32_sdwa v224, 1, v224 dst_sel:DWORD dst_unused:UNUSED_PAD src0_sel:DWORD src1_sel:WORD_1
    v_lshlrev_b32_sdwa v225, 1, v225 dst_sel:DWORD dst_unused:UNUSED_PAD src0_sel:DWORD src1_sel:WORD_1
    v_smfmac_f32_16x16x64_bf16 v[84:87], v[212:215], v[100:107], v7
    v_lshlrev_b32_sdwa v226, 1, v226 dst_sel:DWORD dst_unused:UNUSED_PAD src0_sel:DWORD src1_sel:WORD_1
    v_smfmac_f32_16x16x64_bf16 v[88:91], v[216:219], v[100:107], v7
    v_lshlrev_b32_sdwa v227, 1, v227 dst_sel:DWORD dst_unused:UNUSED_PAD src0_sel:DWORD src1_sel:WORD_1
    v_smfmac_f32_16x16x64_bf16 v[92:95], v[212:215], v[108:115], v7
    v_perm_b32 v172, v149, v148, s30
    v_smfmac_f32_16x16x64_bf16 v[96:99], v[216:219], v[108:115], v7
    v_perm_b32 v173, v151, v150, s30
    v_perm_b32 v174, v153, v152, s30
    v_perm_b32 v175, v155, v154, s30
    ds_read_u16_d16_hi v220, v220 offset:64512
    ds_read_u16_d16_hi v221, v221 offset:64512
    ds_read_u16_d16_hi v222, v222 offset:64512
    ds_read_u16_d16_hi v223, v223 offset:64512
    ds_read_u16_d16_hi v224, v224 offset:64512
    ds_read_u16_d16_hi v225, v225 offset:64512
    ds_read_u16_d16_hi v226, v226 offset:64512
    ds_read_u16_d16_hi v227, v227 offset:64512
    v_perm_b32 v176, v149, v148, s31
    v_perm_b32 v177, v151, v150, s31
    v_perm_b32 v178, v153, v152, s31
    v_perm_b32 v179, v155, v154, s31
    v_lshlrev_b32_sdwa v228, 1, v228 dst_sel:DWORD dst_unused:UNUSED_PAD src0_sel:DWORD src1_sel:WORD_1
    v_lshlrev_b32_sdwa v229, 1, v229 dst_sel:DWORD dst_unused:UNUSED_PAD src0_sel:DWORD src1_sel:WORD_1
    v_mfma_f32_16x16x32_bf16 v[100:103], v[172:175], v[28:31], v[132:135]
    v_lshlrev_b32_sdwa v230, 1, v230 dst_sel:DWORD dst_unused:UNUSED_PAD src0_sel:DWORD src1_sel:WORD_1
    v_lshlrev_b32_sdwa v231, 1, v231 dst_sel:DWORD dst_unused:UNUSED_PAD src0_sel:DWORD src1_sel:WORD_1
    v_mfma_f32_16x16x32_bf16 v[104:107], v[176:179], v[28:31], v[136:139]
    v_lshlrev_b32_sdwa v232, 1, v232 dst_sel:DWORD dst_unused:UNUSED_PAD src0_sel:DWORD src1_sel:WORD_1
    v_lshlrev_b32_sdwa v233, 1, v233 dst_sel:DWORD dst_unused:UNUSED_PAD src0_sel:DWORD src1_sel:WORD_1
    v_mfma_f32_16x16x32_bf16 v[108:111], v[172:175], v[32:35], v[132:135]
    v_lshlrev_b32_sdwa v234, 1, v234 dst_sel:DWORD dst_unused:UNUSED_PAD src0_sel:DWORD src1_sel:WORD_1
    v_lshlrev_b32_sdwa v235, 1, v235 dst_sel:DWORD dst_unused:UNUSED_PAD src0_sel:DWORD src1_sel:WORD_1
    v_mfma_f32_16x16x32_bf16 v[112:115], v[176:179], v[32:35], v[136:139]
    ds_read_u16_d16_hi v228, v228 offset:64512
    ds_read_u16_d16_hi v229, v229 offset:64512
    ds_read_u16_d16_hi v230, v230 offset:64512
    ds_read_u16_d16_hi v231, v231 offset:64512
    ds_read_u16_d16_hi v232, v232 offset:64512
    ds_read_u16_d16_hi v233, v233 offset:64512
    ds_read_u16_d16_hi v234, v234 offset:64512
    ds_read_u16_d16_hi v235, v235 offset:64512
    s_add_u32 s24, s24, 4
    s_cmp_lt_u32 s24, 18
    s_cbranch_scc1 L_L33
L_MID:
    v_add_u32 v146, s1, v145
    s_bitcmp1_b32 s44, 0
    s_cselect_b32 s80, 0, 16
    v_lshlrev_b32_e64 v24, s80, v20
    v_and_b32 v24, 0xffff0000, v24
    s_lshl_b32 s80, s44, 12
    s_mov_b32 m0, s80
    v_mov_b32_e64 v17, 1
    ds_write_addtid_b32 v84 offset:16384
    ds_write_addtid_b32 v85 offset:16640
    ds_write_addtid_b32 v86 offset:16896
    ds_write_addtid_b32 v87 offset:17152
    ds_write_addtid_b32 v88 offset:17408
    ds_write_addtid_b32 v89 offset:17664
    ds_write_addtid_b32 v90 offset:17920
    ds_write_addtid_b32 v91 offset:18176
    ds_write_addtid_b32 v92 offset:18432
    ds_write_addtid_b32 v93 offset:18688
    ds_write_addtid_b32 v94 offset:18944
    ds_write_addtid_b32 v95 offset:19200
    ds_write_addtid_b32 v96 offset:19456
    ds_write_addtid_b32 v97 offset:19712
    ds_write_addtid_b32 v98 offset:19968
    ds_write_addtid_b32 v99 offset:20224
    s_mov_b64 exec, 1
    ds_add_u32 v0, v17
    s_mov_b64 exec, -1
.p2align 3
L_L22:
    s_cmp_ge_u32 s25, 68
    s_cselect_b32 s80, -68, 4
    s_add_u32 s25, s25, s80
    s_lshl_b32 s80, s80, 7
    s_lshl_b32 s81, s80, 5
    v_add_u32 v1, s80, v1
    v_add_u32 v2, s81, v2
    s_waitcnt lgkmcnt(14)
    v_smfmac_f32_16x16x64_bf16 v[52:55], v[212:215], v[116:123], v7
    v_lshlrev_b32_sdwa v100, 1, v100 dst_sel:DWORD dst_unused:UNUSED_PAD src0_sel:DWORD src1_sel:WORD_1
    v_smfmac_f32_16x16x64_bf16 v[56:59], v[216:219], v[116:123], v7
    v_lshlrev_b32_sdwa v101, 1, v101 dst_sel:DWORD dst_unused:UNUSED_PAD src0_sel:DWORD src1_sel:WORD_1
    v_smfmac_f32_16x16x64_bf16 v[60:63], v[212:215], v[124:131], v7
    v_lshlrev_b32_sdwa v102, 1, v102 dst_sel:DWORD dst_unused:UNUSED_PAD src0_sel:DWORD src1_sel:WORD_1
    v_smfmac_f32_16x16x64_bf16 v[64:67], v[216:219], v[124:131], v7
    v_lshlrev_b32_sdwa v103, 1, v103 dst_sel:DWORD dst_unused:UNUSED_PAD src0_sel:DWORD src1_sel:WORD_1
    v_lshlrev_b32_sdwa v104, 1, v104 dst_sel:DWORD dst_unused:UNUSED_PAD src0_sel:DWORD src1_sel:WORD_1
    v_lshlrev_b32_sdwa v105, 1, v105 dst_sel:DWORD dst_unused:UNUSED_PAD src0_sel:DWORD src1_sel:WORD_1
    v_lshlrev_b32_sdwa v106, 1, v106 dst_sel:DWORD dst_unused:UNUSED_PAD src0_sel:DWORD src1_sel:WORD_1
    v_lshlrev_b32_sdwa v107, 1, v107 dst_sel:DWORD dst_unused:UNUSED_PAD src0_sel:DWORD src1_sel:WORD_1
    v_perm_b32 v164, v157, v156, s30
    v_perm_b32 v165, v159, v158, s30
    v_perm_b32 v166, v161, v160, s30
    v_perm_b32 v167, v163, v162, s30
    ds_read_u16_d16_hi v100, v100 offset:64512
    ds_read_u16_d16_hi v101, v101 offset:64512
    ds_read_u16_d16_hi v102, v102 offset:64512
    ds_read_u16_d16_hi v103, v103 offset:64512
    ds_read_u16_d16_hi v104, v104 offset:64512
    ds_read_u16_d16_hi v105, v105 offset:64512
    ds_read_u16_d16_hi v106, v106 offset:64512
    ds_read_u16_d16_hi v107, v107 offset:64512
    v_mfma_f32_16x16x32_bf16 v[236:239], v[172:175], v[36:39], v[132:135]
    v_perm_b32 v168, v157, v156, s31
    v_perm_b32 v169, v159, v158, s31
    v_mfma_f32_16x16x32_bf16 v[240:243], v[176:179], v[36:39], v[136:139]
    v_perm_b32 v170, v161, v160, s31
    v_perm_b32 v171, v163, v162, s31
    v_mfma_f32_16x16x32_bf16 v[244:247], v[172:175], v[40:43], v[132:135]
    v_lshlrev_b32_sdwa v108, 1, v108 dst_sel:DWORD dst_unused:UNUSED_PAD src0_sel:DWORD src1_sel:WORD_1
    v_lshlrev_b32_sdwa v109, 1, v109 dst_sel:DWORD dst_unused:UNUSED_PAD src0_sel:DWORD src1_sel:WORD_1
    v_mfma_f32_16x16x32_bf16 v[248:251], v[176:179], v[40:43], v[136:139]
    v_lshlrev_b32_sdwa v110, 1, v110 dst_sel:DWORD dst_unused:UNUSED_PAD src0_sel:DWORD src1_sel:WORD_1
    v_lshlrev_b32_sdwa v111, 1, v111 dst_sel:DWORD dst_unused:UNUSED_PAD src0_sel:DWORD src1_sel:WORD_1
    v_lshlrev_b32_sdwa v112, 1, v112 dst_sel:DWORD dst_unused:UNUSED_PAD src0_sel:DWORD src1_sel:WORD_1
    v_lshlrev_b32_sdwa v113, 1, v113 dst_sel:DWORD dst_unused:UNUSED_PAD src0_sel:DWORD src1_sel:WORD_1
    v_lshlrev_b32_sdwa v114, 1, v114 dst_sel:DWORD dst_unused:UNUSED_PAD src0_sel:DWORD src1_sel:WORD_1
    v_lshlrev_b32_sdwa v115, 1, v115 dst_sel:DWORD dst_unused:UNUSED_PAD src0_sel:DWORD src1_sel:WORD_1
    ds_read_u16_d16_hi v108, v108 offset:64512
    ds_read_u16_d16_hi v109, v109 offset:64512
    ds_read_u16_d16_hi v110, v110 offset:64512
    ds_read_u16_d16_hi v111, v111 offset:64512
    ds_read_u16_d16_hi v112, v112 offset:64512
    ds_read_u16_d16_hi v113, v113 offset:64512
    ds_read_u16_d16_hi v114, v114 offset:64512
    ds_read_u16_d16_hi v115, v115 offset:64512
    global_load_dword v148, v1, s[48:49] offset:0
    global_load_dword v156, v1, s[48:49] offset:64
    global_load_dword v149, v1, s[50:51] offset:0
    global_load_dword v157, v1, s[50:51] offset:64
    global_load_dword v150, v1, s[52:53] offset:0
    global_load_dword v158, v1, s[52:53] offset:64
    global_load_dword v151, v1, s[54:55] offset:0
    global_load_dword v159, v1, s[54:55] offset:64
    global_load_dword v152, v1, s[56:57] offset:0
    global_load_dword v160, v1, s[56:57] offset:64
    global_load_dword v153, v1, s[58:59] offset:0
    global_load_dword v161, v1, s[58:59] offset:64
    global_load_dword v154, v1, s[60:61] offset:0
    global_load_dword v162, v1, s[60:61] offset:64
    global_load_dword v155, v1, s[62:63] offset:0
    global_load_dword v163, v1, s[62:63] offset:64
    s_waitcnt vmcnt(16) lgkmcnt(14)
    s_nop 0
    v_mfma_f32_16x16x16_bf16 v[132:135], v[4:5], v[206:207], 0
    v_lshlrev_b32_sdwa v236, 1, v236 dst_sel:DWORD dst_unused:UNUSED_PAD src0_sel:DWORD src1_sel:WORD_1
    v_lshlrev_b32_sdwa v237, 1, v237 dst_sel:DWORD dst_unused:UNUSED_PAD src0_sel:DWORD src1_sel:WORD_1
    v_lshlrev_b32_sdwa v238, 1, v238 dst_sel:DWORD dst_unused:UNUSED_PAD src0_sel:DWORD src1_sel:WORD_1
    v_mfma_f32_16x16x16_bf16 v[136:139], v[4:5], v[210:211], 0
    v_lshlrev_b32_sdwa v239, 1, v239 dst_sel:DWORD dst_unused:UNUSED_PAD src0_sel:DWORD src1_sel:WORD_1
    v_lshlrev_b32_sdwa v240, 1, v240 dst_sel:DWORD dst_unused:UNUSED_PAD src0_sel:DWORD src1_sel:WORD_1
    v_lshlrev_b32_sdwa v241, 1, v241 dst_sel:DWORD dst_unused:UNUSED_PAD src0_sel:DWORD src1_sel:WORD_1
    v_smfmac_f32_16x16x64_bf16 v[68:71], v[212:215], v[220:227], v7
    v_lshlrev_b32_sdwa v242, 1, v242 dst_sel:DWORD dst_unused:UNUSED_PAD src0_sel:DWORD src1_sel:WORD_1
    v_smfmac_f32_16x16x64_bf16 v[72:75], v[216:219], v[220:227], v7
    v_lshlrev_b32_sdwa v243, 1, v243 dst_sel:DWORD dst_unused:UNUSED_PAD src0_sel:DWORD src1_sel:WORD_1
    v_smfmac_f32_16x16x64_bf16 v[76:79], v[212:215], v[228:235], v7
    v_perm_b32 v188, v181, v180, s30
    v_smfmac_f32_16x16x64_bf16 v[80:83], v[216:219], v[228:235], v7
    v_perm_b32 v189, v183, v182, s30
    v_perm_b32 v190, v185, v184, s30
    v_perm_b32 v191, v187, v186, s30
    ds_read_u16_d16_hi v236, v236 offset:64512
    ds_read_u16_d16_hi v237, v237 offset:64512
    ds_read_u16_d16_hi v238, v238 offset:64512
    ds_read_u16_d16_hi v239, v239 offset:64512
    ds_read_u16_d16_hi v240, v240 offset:64512
    ds_read_u16_d16_hi v241, v241 offset:64512
    ds_read_u16_d16_hi v242, v242 offset:64512
    ds_read_u16_d16_hi v243, v243 offset:64512
    v_mfma_f32_16x16x32_bf16 v[116:119], v[164:167], v[28:31], v[132:135]
    v_perm_b32 v192, v181, v180, s31
    v_perm_b32 v193, v183, v182, s31
    v_mfma_f32_16x16x32_bf16 v[120:123], v[168:171], v[28:31], v[136:139]
    v_perm_b32 v194, v185, v184, s31
    v_perm_b32 v195, v187, v186, s31
    v_mfma_f32_16x16x32_bf16 v[124:127], v[164:167], v[32:35], v[132:135]
    v_lshlrev_b32_sdwa v244, 1, v244 dst_sel:DWORD dst_unused:UNUSED_PAD src0_sel:DWORD src1_sel:WORD_1
    v_lshlrev_b32_sdwa v245, 1, v245 dst_sel:DWORD dst_unused:UNUSED_PAD src0_sel:DWORD src1_sel:WORD_1
    v_mfma_f32_16x16x32_bf16 v[128:131], v[168:171], v[32:35], v[136:139]
    v_lshlrev_b32_sdwa v246, 1, v246 dst_sel:DWORD dst_unused:UNUSED_PAD src0_sel:DWORD src1_sel:WORD_1
    v_lshlrev_b32_sdwa v247, 1, v247 dst_sel:DWORD dst_unused:UNUSED_PAD src0_sel:DWORD src1_sel:WORD_1
    v_lshlrev_b32_sdwa v248, 1, v248 dst_sel:DWORD dst_unused:UNUSED_PAD src0_sel:DWORD src1_sel:WORD_1
    v_lshlrev_b32_sdwa v249, 1, v249 dst_sel:DWORD dst_unused:UNUSED_PAD src0_sel:DWORD src1_sel:WORD_1
    v_lshlrev_b32_sdwa v250, 1, v250 dst_sel:DWORD dst_unused:UNUSED_PAD src0_sel:DWORD src1_sel:WORD_1
    v_lshlrev_b32_sdwa v251, 1, v251 dst_sel:DWORD dst_unused:UNUSED_PAD src0_sel:DWORD src1_sel:WORD_1
    ds_read_u16_d16_hi v244, v244 offset:64512
    ds_read_u16_d16_hi v245, v245 offset:64512
    ds_read_u16_d16_hi v246, v246 offset:64512
    ds_read_u16_d16_hi v247, v247 offset:64512
    ds_read_u16_d16_hi v248, v248 offset:64512
    ds_read_u16_d16_hi v249, v249 offset:64512
    ds_read_u16_d16_hi v250, v250 offset:64512
    ds_read_u16_d16_hi v251, v251 offset:64512
    ds_read_b32 v15, v6 offset:4
    buffer_load_dword v4, v1, s[32:35], 0 offen offset:0
    buffer_load_dword v5, v1, s[32:35], 0 offen offset:64
    global_load_dword v180, v2, s[10:11] offset:0
    global_load_dword v181, v2, s[10:11] offset:128
    global_load_dword v182, v2, s[10:11] offset:256
    global_load_dword v183, v2, s[10:11] offset:384
    global_load_dword v184, v2, s[10:11] offset:512
    global_load_dword v185, v2, s[10:11] offset:640
    global_load_dword v186, v2, s[10:11] offset:768
    global_load_dword v187, v2, s[10:11] offset:896
    s_waitcnt lgkmcnt(14)
    s_nop 0
    v_smfmac_f32_16x16x64_bf16 v[52:55], v[188:191], v[100:107], v7
    v_lshlrev_b32_sdwa v116, 1, v116 dst_sel:DWORD dst_unused:UNUSED_PAD src0_sel:DWORD src1_sel:WORD_1
    v_smfmac_f32_16x16x64_bf16 v[56:59], v[192:195], v[100:107], v7
    v_lshlrev_b32_sdwa v117, 1, v117 dst_sel:DWORD dst_unused:UNUSED_PAD src0_sel:DWORD src1_sel:WORD_1
    v_smfmac_f32_16x16x64_bf16 v[60:63], v[188:191], v[108:115], v7
    v_lshlrev_b32_sdwa v118, 1, v118 dst_sel:DWORD dst_unused:UNUSED_PAD src0_sel:DWORD src1_sel:WORD_1
    v_smfmac_f32_16x16x64_bf16 v[64:67], v[192:195], v[108:115], v7
    v_lshlrev_b32_sdwa v119, 1, v119 dst_sel:DWORD dst_unused:UNUSED_PAD src0_sel:DWORD src1_sel:WORD_1
    v_lshlrev_b32_sdwa v120, 1, v120 dst_sel:DWORD dst_unused:UNUSED_PAD src0_sel:DWORD src1_sel:WORD_1
    v_lshlrev_b32_sdwa v121, 1, v121 dst_sel:DWORD dst_unused:UNUSED_PAD src0_sel:DWORD src1_sel:WORD_1
    v_lshlrev_b32_sdwa v122, 1, v122 dst_sel:DWORD dst_unused:UNUSED_PAD src0_sel:DWORD src1_sel:WORD_1
    v_lshlrev_b32_sdwa v123, 1, v123 dst_sel:DWORD dst_unused:UNUSED_PAD src0_sel:DWORD src1_sel:WORD_1
    v_perm_b32 v212, v197, v196, s30
    v_perm_b32 v213, v199, v198, s30
    v_perm_b32 v214, v201, v200, s30
    v_perm_b32 v215, v203, v202, s30
    ds_read_u16_d16_hi v116, v116 offset:64512
    ds_read_u16_d16_hi v117, v117 offset:64512
    ds_read_u16_d16_hi v118, v118 offset:64512
    ds_read_u16_d16_hi v119, v119 offset:64512
    ds_read_u16_d16_hi v120, v120 offset:64512
    ds_read_u16_d16_hi v121, v121 offset:64512
    ds_read_u16_d16_hi v122, v122 offset:64512
    ds_read_u16_d16_hi v123, v123 offset:64512
    v_mfma_f32_16x16x32_bf16 v[220:223], v[164:167], v[36:39], v[132:135]
    v_perm_b32 v216, v197, v196, s31
    v_perm_b32 v217, v199, v198, s31
    v_mfma_f32_16x16x32_bf16 v[224:227], v[168:171], v[36:39], v[136:139]
    v_perm_b32 v218, v201, v200, s31
    v_perm_b32 v219, v203, v202, s31
    v_mfma_f32_16x16x32_bf16 v[228:231], v[164:167], v[40:43], v[132:135]
    v_lshlrev_b32_sdwa v124, 1, v124 dst_sel:DWORD dst_unused:UNUSED_PAD src0_sel:DWORD src1_sel:WORD_1
    v_lshlrev_b32_sdwa v125, 1, v125 dst_sel:DWORD dst_unused:UNUSED_PAD src0_sel:DWORD src1_sel:WORD_1
    v_mfma_f32_16x16x32_bf16 v[232:235], v[168:171], v[40:43], v[136:139]
    v_lshlrev_b32_sdwa v126, 1, v126 dst_sel:DWORD dst_unused:UNUSED_PAD src0_sel:DWORD src1_sel:WORD_1
    v_lshlrev_b32_sdwa v127, 1, v127 dst_sel:DWORD dst_unused:UNUSED_PAD src0_sel:DWORD src1_sel:WORD_1
    v_lshlrev_b32_sdwa v128, 1, v128 dst_sel:DWORD dst_unused:UNUSED_PAD src0_sel:DWORD src1_sel:WORD_1
    v_lshlrev_b32_sdwa v129, 1, v129 dst_sel:DWORD dst_unused:UNUSED_PAD src0_sel:DWORD src1_sel:WORD_1
    v_lshlrev_b32_sdwa v130, 1, v130 dst_sel:DWORD dst_unused:UNUSED_PAD src0_sel:DWORD src1_sel:WORD_1
    v_lshlrev_b32_sdwa v131, 1, v131 dst_sel:DWORD dst_unused:UNUSED_PAD src0_sel:DWORD src1_sel:WORD_1
    ds_read_u16_d16_hi v124, v124 offset:64512
    ds_read_u16_d16_hi v125, v125 offset:64512
    ds_read_u16_d16_hi v126, v126 offset:64512
    ds_read_u16_d16_hi v127, v127 offset:64512
    ds_read_u16_d16_hi v128, v128 offset:64512
    ds_read_u16_d16_hi v129, v129 offset:64512
    ds_read_u16_d16_hi v130, v130 offset:64512
    ds_read_u16_d16_hi v131, v131 offset:64512
    global_load_dword v196, v2, s[10:11] offset:2048
    global_load_dword v197, v2, s[10:11] offset:2176
    global_load_dword v198, v2, s[10:11] offset:2304
    global_load_dword v199, v2, s[10:11] offset:2432
    global_load_dword v200, v2, s[10:11] offset:2560
    global_load_dword v201, v2, s[10:11] offset:2688
    global_load_dword v202, v2, s[10:11] offset:2816
    global_load_dword v203, v2, s[10:11] offset:2944
    s_waitcnt vmcnt(16) lgkmcnt(14)
    s_nop 0
    v_mfma_f32_16x16x16_bf16 v[132:135], v[4:5], v[204:205], 0
    v_lshlrev_b32_sdwa v220, 1, v220 dst_sel:DWORD dst_unused:UNUSED_PAD src0_sel:DWORD src1_sel:WORD_1
    v_lshlrev_b32_sdwa v221, 1, v221 dst_sel:DWORD dst_unused:UNUSED_PAD src0_sel:DWORD src1_sel:WORD_1
    v_lshlrev_b32_sdwa v222, 1, v222 dst_sel:DWORD dst_unused:UNUSED_PAD src0_sel:DWORD src1_sel:WORD_1
    v_mfma_f32_16x16x16_bf16 v[136:139], v[4:5], v[208:209], 0
    v_lshlrev_b32_sdwa v223, 1, v223 dst_sel:DWORD dst_unused:UNUSED_PAD src0_sel:DWORD src1_sel:WORD_1
    v_lshlrev_b32_sdwa v224, 1, v224 dst_sel:DWORD dst_unused:UNUSED_PAD src0_sel:DWORD src1_sel:WORD_1
    v_lshlrev_b32_sdwa v225, 1, v225 dst_sel:DWORD dst_unused:UNUSED_PAD src0_sel:DWORD src1_sel:WORD_1
    v_smfmac_f32_16x16x64_bf16 v[68:71], v[188:191], v[236:243], v7
    v_lshlrev_b32_sdwa v226, 1, v226 dst_sel:DWORD dst_unused:UNUSED_PAD src0_sel:DWORD src1_sel:WORD_1
    v_smfmac_f32_16x16x64_bf16 v[72:75], v[192:195], v[236:243], v7
    v_lshlrev_b32_sdwa v227, 1, v227 dst_sel:DWORD dst_unused:UNUSED_PAD src0_sel:DWORD src1_sel:WORD_1
    v_smfmac_f32_16x16x64_bf16 v[76:79], v[188:191], v[244:251], v7
    v_perm_b32 v172, v149, v148, s30
    v_smfmac_f32_16x16x64_bf16 v[80:83], v[192:195], v[244:251], v7
    v_perm_b32 v173, v151, v150, s30
    v_perm_b32 v174, v153, v152, s30
    v_perm_b32 v175, v155, v154, s30
    ds_read_u16_d16_hi v220, v220 offset:64512
    ds_read_u16_d16_hi v221, v221 offset:64512
    ds_read_u16_d16_hi v222, v222 offset:64512
    ds_read_u16_d16_hi v223, v223 offset:64512
    ds_read_u16_d16_hi v224, v224 offset:64512
    ds_read_u16_d16_hi v225, v225 offset:64512
    ds_read_u16_d16_hi v226, v226 offset:64512
    ds_read_u16_d16_hi v227, v227 offset:64512
    v_perm_b32 v176, v149, v148, s31
    v_perm_b32 v177, v151, v150, s31
    v_perm_b32 v178, v153, v152, s31
    v_perm_b32 v179, v155, v154, s31
    v_lshlrev_b32_sdwa v228, 1, v228 dst_sel:DWORD dst_unused:UNUSED_PAD src0_sel:DWORD src1_sel:WORD_1
    v_lshlrev_b32_sdwa v229, 1, v229 dst_sel:DWORD dst_unused:UNUSED_PAD src0_sel:DWORD src1_sel:WORD_1
    v_mfma_f32_16x16x32_bf16 v[100:103], v[172:175], v[28:31], v[132:135]
    v_lshlrev_b32_sdwa v230, 1, v230 dst_sel:DWORD dst_unused:UNUSED_PAD src0_sel:DWORD src1_sel:WORD_1
    v_lshlrev_b32_sdwa v231, 1, v231 dst_sel:DWORD dst_unused:UNUSED_PAD src0_sel:DWORD src1_sel:WORD_1
    v_mfma_f32_16x16x32_bf16 v[104:107], v[176:179], v[28:31], v[136:139]
    v_lshlrev_b32_sdwa v232, 1, v232 dst_sel:DWORD dst_unused:UNUSED_PAD src0_sel:DWORD src1_sel:WORD_1
    v_lshlrev_b32_sdwa v233, 1, v233 dst_sel:DWORD dst_unused:UNUSED_PAD src0_sel:DWORD src1_sel:WORD_1
    v_mfma_f32_16x16x32_bf16 v[108:111], v[172:175], v[32:35], v[132:135]
    v_lshlrev_b32_sdwa v234, 1, v234 dst_sel:DWORD dst_unused:UNUSED_PAD src0_sel:DWORD src1_sel:WORD_1
    v_lshlrev_b32_sdwa v235, 1, v235 dst_sel:DWORD dst_unused:UNUSED_PAD src0_sel:DWORD src1_sel:WORD_1
    v_mfma_f32_16x16x32_bf16 v[112:115], v[176:179], v[32:35], v[136:139]
    ds_read_u16_d16_hi v228, v228 offset:64512
    ds_read_u16_d16_hi v229, v229 offset:64512
    ds_read_u16_d16_hi v230, v230 offset:64512
    ds_read_u16_d16_hi v231, v231 offset:64512
    ds_read_u16_d16_hi v232, v232 offset:64512
    ds_read_u16_d16_hi v233, v233 offset:64512
    ds_read_u16_d16_hi v234, v234 offset:64512
    ds_read_u16_d16_hi v235, v235 offset:64512
    s_add_u32 s24, s24, 4
    s_cmp_lt_u32 s24, s21
    s_cbranch_scc1 L_L22
    s_bitcmp1_b32 s44, 1
    s_cbranch_scc1 L_DLb
L_DLa:
    ds_read_b32 v15, v6 offset:4
    s_waitcnt lgkmcnt(14)
    v_mfma_f32_16x16x16_bf16 v[132:135], v[4:5], v[206:207], 0
    v_lshlrev_b32_sdwa v100, 1, v100 dst_sel:DWORD dst_unused:UNUSED_PAD src0_sel:DWORD src1_sel:WORD_1
    v_lshlrev_b32_sdwa v101, 1, v101 dst_sel:DWORD dst_unused:UNUSED_PAD src0_sel:DWORD src1_sel:WORD_1
    v_lshlrev_b32_sdwa v102, 1, v102 dst_sel:DWORD dst_unused:UNUSED_PAD src0_sel:DWORD src1_sel:WORD_1
    v_mfma_f32_16x16x16_bf16 v[136:139], v[4:5], v[210:211], 0
    v_lshlrev_b32_sdwa v103, 1, v103 dst_sel:DWORD dst_unused:UNUSED_PAD src0_sel:DWORD src1_sel:WORD_1
    v_lshlrev_b32_sdwa v104, 1, v104 dst_sel:DWORD dst_unused:UNUSED_PAD src0_sel:DWORD src1_sel:WORD_1
    v_lshlrev_b32_sdwa v105, 1, v105 dst_sel:DWORD dst_unused:UNUSED_PAD src0_sel:DWORD src1_sel:WORD_1
    v_smfmac_f32_16x16x64_bf16 v[52:55], v[212:215], v[116:123], v7
    v_lshlrev_b32_sdwa v106, 1, v106 dst_sel:DWORD dst_unused:UNUSED_PAD src0_sel:DWORD src1_sel:WORD_1
    v_smfmac_f32_16x16x64_bf16 v[56:59], v[216:219], v[116:123], v7
    v_lshlrev_b32_sdwa v107, 1, v107 dst_sel:DWORD dst_unused:UNUSED_PAD src0_sel:DWORD src1_sel:WORD_1
    v_smfmac_f32_16x16x64_bf16 v[60:63], v[212:215], v[124:131], v7
    v_perm_b32 v164, v157, v156, s30
    v_smfmac_f32_16x16x64_bf16 v[64:67], v[216:219], v[124:131], v7
    v_perm_b32 v165, v159, v158, s30
    v_perm_b32 v166, v161, v160, s30
    v_perm_b32 v167, v163, v162, s30
    ds_read_u16_d16_hi v100, v100 offset:64512
    ds_read_u16_d16_hi v101, v101 offset:64512
    ds_read_u16_d16_hi v102, v102 offset:64512
    ds_read_u16_d16_hi v103, v103 offset:64512
    ds_read_u16_d16_hi v104, v104 offset:64512
    ds_read_u16_d16_hi v105, v105 offset:64512
    ds_read_u16_d16_hi v106, v106 offset:64512
    ds_read_u16_d16_hi v107, v107 offset:64512
    v_perm_b32 v168, v157, v156, s31
    v_perm_b32 v169, v159, v158, s31
    v_perm_b32 v170, v161, v160, s31
    v_perm_b32 v171, v163, v162, s31
    v_lshlrev_b32_sdwa v108, 1, v108 dst_sel:DWORD dst_unused:UNUSED_PAD src0_sel:DWORD src1_sel:WORD_1
    v_lshlrev_b32_sdwa v109, 1, v109 dst_sel:DWORD dst_unused:UNUSED_PAD src0_sel:DWORD src1_sel:WORD_1
    v_mfma_f32_16x16x32_bf16 v[236:239], v[164:167], v[36:39], v[132:135]
    v_lshlrev_b32_sdwa v110, 1, v110 dst_sel:DWORD dst_unused:UNUSED_PAD src0_sel:DWORD src1_sel:WORD_1
    v_lshlrev_b32_sdwa v111, 1, v111 dst_sel:DWORD dst_unused:UNUSED_PAD src0_sel:DWORD src1_sel:WORD_1
    v_mfma_f32_16x16x32_bf16 v[240:243], v[168:171], v[36:39], v[136:139]
    v_lshlrev_b32_sdwa v112, 1, v112 dst_sel:DWORD dst_unused:UNUSED_PAD src0_sel:DWORD src1_sel:WORD_1
    v_lshlrev_b32_sdwa v113, 1, v113 dst_sel:DWORD dst_unused:UNUSED_PAD src0_sel:DWORD src1_sel:WORD_1
    v_mfma_f32_16x16x32_bf16 v[244:247], v[164:167], v[40:43], v[132:135]
    v_lshlrev_b32_sdwa v114, 1, v114 dst_sel:DWORD dst_unused:UNUSED_PAD src0_sel:DWORD src1_sel:WORD_1
    v_lshlrev_b32_sdwa v115, 1, v115 dst_sel:DWORD dst_unused:UNUSED_PAD src0_sel:DWORD src1_sel:WORD_1
    v_mfma_f32_16x16x32_bf16 v[248:251], v[168:171], v[40:43], v[136:139]
    ds_read_u16_d16_hi v108, v108 offset:64512
    ds_read_u16_d16_hi v109, v109 offset:64512
    ds_read_u16_d16_hi v110, v110 offset:64512
    ds_read_u16_d16_hi v111, v111 offset:64512
    ds_read_u16_d16_hi v112, v112 offset:64512
    ds_read_u16_d16_hi v113, v113 offset:64512
    ds_read_u16_d16_hi v114, v114 offset:64512
    ds_read_u16_d16_hi v115, v115 offset:64512
    s_waitcnt vmcnt(0) lgkmcnt(14)
    s_nop 0
    v_smfmac_f32_16x16x64_bf16 v[68:71], v[212:215], v[220:227], v7
    v_lshlrev_b32_sdwa v236, 1, v236 dst_sel:DWORD dst_unused:UNUSED_PAD src0_sel:DWORD src1_sel:WORD_1
    v_smfmac_f32_16x16x64_bf16 v[72:75], v[216:219], v[220:227], v7
    v_lshlrev_b32_sdwa v237, 1, v237 dst_sel:DWORD dst_unused:UNUSED_PAD src0_sel:DWORD src1_sel:WORD_1
    v_smfmac_f32_16x16x64_bf16 v[76:79], v[212:215], v[228:235], v7
    v_lshlrev_b32_sdwa v238, 1, v238 dst_sel:DWORD dst_unused:UNUSED_PAD src0_sel:DWORD src1_sel:WORD_1
    v_smfmac_f32_16x16x64_bf16 v[80:83], v[216:219], v[228:235], v7
    v_lshlrev_b32_sdwa v239, 1, v239 dst_sel:DWORD dst_unused:UNUSED_PAD src0_sel:DWORD src1_sel:WORD_1
    v_lshlrev_b32_sdwa v240, 1, v240 dst_sel:DWORD dst_unused:UNUSED_PAD src0_sel:DWORD src1_sel:WORD_1
    v_lshlrev_b32_sdwa v241, 1, v241 dst_sel:DWORD dst_unused:UNUSED_PAD src0_sel:DWORD src1_sel:WORD_1
    v_lshlrev_b32_sdwa v242, 1, v242 dst_sel:DWORD dst_unused:UNUSED_PAD src0_sel:DWORD src1_sel:WORD_1
    v_lshlrev_b32_sdwa v243, 1, v243 dst_sel:DWORD dst_unused:UNUSED_PAD src0_sel:DWORD src1_sel:WORD_1
    v_perm_b32 v188, v181, v180, s30
    v_perm_b32 v189, v183, v182, s30
    v_perm_b32 v190, v185, v184, s30
    v_perm_b32 v191, v187, v186, s30
    ds_read_u16_d16_hi v236, v236 offset:64512
    ds_read_u16_d16_hi v237, v237 offset:64512
    ds_read_u16_d16_hi v238, v238 offset:64512
    ds_read_u16_d16_hi v239, v239 offset:64512
    ds_read_u16_d16_hi v240, v240 offset:64512
    ds_read_u16_d16_hi v241, v241 offset:64512
    ds_read_u16_d16_hi v242, v242 offset:64512
    ds_read_u16_d16_hi v243, v243 offset:64512
    v_mfma_f32_16x16x32_bf16 v[116:119], v[164:167], v[28:31], v[132:135]
    v_perm_b32 v192, v181, v180, s31
    v_perm_b32 v193, v183, v182, s31
    v_mfma_f32_16x16x32_bf16 v[120:123], v[168:171], v[28:31], v[136:139]
    v_perm_b32 v194, v185, v184, s31
    v_perm_b32 v195, v187, v186, s31
    v_mfma_f32_16x16x32_bf16 v[124:127], v[164:167], v[32:35], v[132:135]
    v_lshlrev_b32_sdwa v244, 1, v244 dst_sel:DWORD dst_unused:UNUSED_PAD src0_sel:DWORD src1_sel:WORD_1
    v_lshlrev_b32_sdwa v245, 1, v245 dst_sel:DWORD dst_unused:UNUSED_PAD src0_sel:DWORD src1_sel:WORD_1
    v_mfma_f32_16x16x32_bf16 v[128:131], v[168:171], v[32:35], v[136:139]
    v_lshlrev_b32_sdwa v246, 1, v246 dst_sel:DWORD dst_unused:UNUSED_PAD src0_sel:DWORD src1_sel:WORD_1
    v_lshlrev_b32_sdwa v247, 1, v247 dst_sel:DWORD dst_unused:UNUSED_PAD src0_sel:DWORD src1_sel:WORD_1
    v_lshlrev_b32_sdwa v248, 1, v248 dst_sel:DWORD dst_unused:UNUSED_PAD src0_sel:DWORD src1_sel:WORD_1
    v_lshlrev_b32_sdwa v249, 1, v249 dst_sel:DWORD dst_unused:UNUSED_PAD src0_sel:DWORD src1_sel:WORD_1
    v_lshlrev_b32_sdwa v250, 1, v250 dst_sel:DWORD dst_unused:UNUSED_PAD src0_sel:DWORD src1_sel:WORD_1
    v_lshlrev_b32_sdwa v251, 1, v251 dst_sel:DWORD dst_unused:UNUSED_PAD src0_sel:DWORD src1_sel:WORD_1
    ds_read_u16_d16_hi v244, v244 offset:64512
    ds_read_u16_d16_hi v245, v245 offset:64512
    ds_read_u16_d16_hi v246, v246 offset:64512
    ds_read_u16_d16_hi v247, v247 offset:64512
    ds_read_u16_d16_hi v248, v248 offset:64512
    ds_read_u16_d16_hi v249, v249 offset:64512
    ds_read_u16_d16_hi v250, v250 offset:64512
    ds_read_u16_d16_hi v251, v251 offset:64512
    s_waitcnt lgkmcnt(14)
    s_nop 0
    v_smfmac_f32_16x16x64_bf16 v[52:55], v[188:191], v[100:107], v7
    v_lshlrev_b32_sdwa v116, 1, v116 dst_sel:DWORD dst_unused:UNUSED_PAD src0_sel:DWORD src1_sel:WORD_1
    v_smfmac_f32_16x16x64_bf16 v[56:59], v[192:195], v[100:107], v7
    v_lshlrev_b32_sdwa v117, 1, v117 dst_sel:DWORD dst_unused:UNUSED_PAD src0_sel:DWORD src1_sel:WORD_1
    v_smfmac_f32_16x16x64_bf16 v[60:63], v[188:191], v[108:115], v7
    v_lshlrev_b32_sdwa v118, 1, v118 dst_sel:DWORD dst_unused:UNUSED_PAD src0_sel:DWORD src1_sel:WORD_1
    v_smfmac_f32_16x16x64_bf16 v[64:67], v[192:195], v[108:115], v7
    v_lshlrev_b32_sdwa v119, 1, v119 dst_sel:DWORD dst_unused:UNUSED_PAD src0_sel:DWORD src1_sel:WORD_1
    v_lshlrev_b32_sdwa v120, 1, v120 dst_sel:DWORD dst_unused:UNUSED_PAD src0_sel:DWORD src1_sel:WORD_1
    v_lshlrev_b32_sdwa v121, 1, v121 dst_sel:DWORD dst_unused:UNUSED_PAD src0_sel:DWORD src1_sel:WORD_1
    v_lshlrev_b32_sdwa v122, 1, v122 dst_sel:DWORD dst_unused:UNUSED_PAD src0_sel:DWORD src1_sel:WORD_1
    v_lshlrev_b32_sdwa v123, 1, v123 dst_sel:DWORD dst_unused:UNUSED_PAD src0_sel:DWORD src1_sel:WORD_1
    v_perm_b32 v212, v197, v196, s30
    v_perm_b32 v213, v199, v198, s30
    v_perm_b32 v214, v201, v200, s30
    v_perm_b32 v215, v203, v202, s30
    ds_read_u16_d16_hi v116, v116 offset:64512
    ds_read_u16_d16_hi v117, v117 offset:64512
    ds_read_u16_d16_hi v118, v118 offset:64512
    ds_read_u16_d16_hi v119, v119 offset:64512
    ds_read_u16_d16_hi v120, v120 offset:64512
    ds_read_u16_d16_hi v121, v121 offset:64512
    ds_read_u16_d16_hi v122, v122 offset:64512
    ds_read_u16_d16_hi v123, v123 offset:64512
    v_perm_b32 v216, v197, v196, s31
    v_perm_b32 v217, v199, v198, s31
    v_perm_b32 v218, v201, v200, s31
    v_perm_b32 v219, v203, v202, s31
    v_lshlrev_b32_sdwa v124, 1, v124 dst_sel:DWORD dst_unused:UNUSED_PAD src0_sel:DWORD src1_sel:WORD_1
    v_lshlrev_b32_sdwa v125, 1, v125 dst_sel:DWORD dst_unused:UNUSED_PAD src0_sel:DWORD src1_sel:WORD_1
    v_lshlrev_b32_sdwa v126, 1, v126 dst_sel:DWORD dst_unused:UNUSED_PAD src0_sel:DWORD src1_sel:WORD_1
    v_lshlrev_b32_sdwa v127, 1, v127 dst_sel:DWORD dst_unused:UNUSED_PAD src0_sel:DWORD src1_sel:WORD_1
    v_lshlrev_b32_sdwa v128, 1, v128 dst_sel:DWORD dst_unused:UNUSED_PAD src0_sel:DWORD src1_sel:WORD_1
    v_lshlrev_b32_sdwa v129, 1, v129 dst_sel:DWORD dst_unused:UNUSED_PAD src0_sel:DWORD src1_sel:WORD_1
    v_lshlrev_b32_sdwa v130, 1, v130 dst_sel:DWORD dst_unused:UNUSED_PAD src0_sel:DWORD src1_sel:WORD_1
    v_lshlrev_b32_sdwa v131, 1, v131 dst_sel:DWORD dst_unused:UNUSED_PAD src0_sel:DWORD src1_sel:WORD_1
    ds_read_u16_d16_hi v124, v124 offset:64512
    ds_read_u16_d16_hi v125, v125 offset:64512
    ds_read_u16_d16_hi v126, v126 offset:64512
    ds_read_u16_d16_hi v127, v127 offset:64512
    ds_read_u16_d16_hi v128, v128 offset:64512
    ds_read_u16_d16_hi v129, v129 offset:64512
    ds_read_u16_d16_hi v130, v130 offset:64512
    ds_read_u16_d16_hi v131, v131 offset:64512
    s_waitcnt lgkmcnt(14)
    v_smfmac_f32_16x16x64_bf16 v[68:71], v[212:215], v[236:243], v7
    v_smfmac_f32_16x16x64_bf16 v[72:75], v[216:219], v[236:243], v7
    v_smfmac_f32_16x16x64_bf16 v[76:79], v[212:215], v[244:251], v7
    v_smfmac_f32_16x16x64_bf16 v[80:83], v[216:219], v[244:251], v7
    v_readfirstlane_b32 s80, v15
L_spinDLa:
    s_lshl_b32 m0, s44, 10
    s_nop 2
    s_cmp_lg_u32 s80, 6
    s_cbranch_scc1 L_respinDLa
    ds_write_addtid_b32 v68 offset:32768
    ds_write_addtid_b32 v69 offset:33024
    ds_write_addtid_b32 v70 offset:33280
    ds_write_addtid_b32 v71 offset:33536
    ds_write_addtid_b32 v72 offset:40960
    ds_write_addtid_b32 v73 offset:41216
    ds_write_addtid_b32 v74 offset:41472
    ds_write_addtid_b32 v75 offset:41728
    ds_write_addtid_b32 v76 offset:49152
    ds_write_addtid_b32 v77 offset:49408
    ds_write_addtid_b32 v78 offset:49664
    ds_write_addtid_b32 v79 offset:49920
    ds_write_addtid_b32 v80 offset:57344
    ds_write_addtid_b32 v81 offset:57600
    ds_write_addtid_b32 v82 offset:57856
    ds_write_addtid_b32 v83 offset:58112
    s_waitcnt lgkmcnt(14)
    v_smfmac_f32_16x16x64_bf16 v[52:55], v[212:215], v[116:123], v7
    v_smfmac_f32_16x16x64_bf16 v[56:59], v[216:219], v[116:123], v7
    v_smfmac_f32_16x16x64_bf16 v[60:63], v[212:215], v[124:131], v7
    v_smfmac_f32_16x16x64_bf16 v[64:67], v[216:219], v[124:131], v7
    s_nop 4
    s_cmp_eq_u32 s44, 0
    s_cbranch_scc1 L_ew0DLa
    ds_write_addtid_b32 v52 offset:0
    ds_write_addtid_b32 v53 offset:256
    ds_write_addtid_b32 v54 offset:512
    ds_write_addtid_b32 v55 offset:768
L_ew0DLa:
    ds_write_addtid_b32 v56 offset:8192
    ds_write_addtid_b32 v57 offset:8448
    ds_write_addtid_b32 v58 offset:8704
    ds_write_addtid_b32 v59 offset:8960
    ds_write_addtid_b32 v60 offset:16384
    ds_write_addtid_b32 v61 offset:16640
    ds_write_addtid_b32 v62 offset:16896
    ds_write_addtid_b32 v63 offset:17152
    ds_write_addtid_b32 v64 offset:24576
    ds_write_addtid_b32 v65 offset:24832
    ds_write_addtid_b32 v66 offset:25088
    ds_write_addtid_b32 v67 offset:25344
    s_branch L_EPI
L_DLb:
    s_waitcnt lgkmcnt(14)
    v_smfmac_f32_16x16x64_bf16 v[52:55], v[212:215], v[116:123], v7
    v_smfmac_f32_16x16x64_bf16 v[56:59], v[216:219], v[116:123], v7
    v_smfmac_f32_16x16x64_bf16 v[60:63], v[212:215], v[124:131], v7
    v_smfmac_f32_16x16x64_bf16 v[64:67], v[216:219], v[124:131], v7
    v_readfirstlane_b32 s80, v15
L_spinDLb:
    s_lshl_b32 m0, s44, 10
    s_nop 2
    s_cmp_lg_u32 s80, 6
    s_cbranch_scc1 L_respinDLb
    s_nop 0
    ds_write_addtid_b32 v52 offset:0
    ds_write_addtid_b32 v53 offset:256
    ds_write_addtid_b32 v54 offset:512
    ds_write_addtid_b32 v55 offset:768
    ds_write_addtid_b32 v56 offset:8192
    ds_write_addtid_b32 v57 offset:8448
    ds_write_addtid_b32 v58 offset:8704
    ds_write_addtid_b32 v59 offset:8960
    ds_write_addtid_b32 v60 offset:16384
    ds_write_addtid_b32 v61 offset:16640
    ds_write_addtid_b32 v62 offset:16896
    ds_write_addtid_b32 v63 offset:17152
    ds_write_addtid_b32 v64 offset:24576
    ds_write_addtid_b32 v65 offset:24832
    ds_write_addtid_b32 v66 offset:25088
    ds_write_addtid_b32 v67 offset:25344
    s_waitcnt lgkmcnt(14)
    v_smfmac_f32_16x16x64_bf16 v[68:71], v[212:215], v[220:227], v7
    v_smfmac_f32_16x16x64_bf16 v[72:75], v[216:219], v[220:227], v7
    v_smfmac_f32_16x16x64_bf16 v[76:79], v[212:215], v[228:235], v7
    v_smfmac_f32_16x16x64_bf16 v[80:83], v[216:219], v[228:235], v7
    s_nop 4
    ds_write_addtid_b32 v68 offset:32768
    ds_write_addtid_b32 v69 offset:33024
    ds_write_addtid_b32 v70 offset:33280
    ds_write_addtid_b32 v71 offset:33536
    ds_write_addtid_b32 v72 offset:40960
    ds_write_addtid_b32 v73 offset:41216
    ds_write_addtid_b32 v74 offset:41472
    ds_write_addtid_b32 v75 offset:41728
    ds_write_addtid_b32 v76 offset:49152
    ds_write_addtid_b32 v77 offset:49408
    ds_write_addtid_b32 v78 offset:49664
    ds_write_addtid_b32 v79 offset:49920
    ds_write_addtid_b32 v80 offset:57344
    ds_write_addtid_b32 v81 offset:57600
    ds_write_addtid_b32 v82 offset:57856
    ds_write_addtid_b32 v83 offset:58112
    s_branch L_EPI
L_respinDLa:
    ds_read_b32 v15, v6 offset:4
    s_waitcnt lgkmcnt(0)
    v_readfirstlane_b32 s80, v15
    s_branch L_spinDLa
L_FIN:
    s_waitcnt vmcnt(0)
    s_getpc_b64 s[22:23]
    s_cmp_lg_u32 s3, 0
    s_cbranch_scc1 L_HANDLER
    s_cmp_lg_u32 s3, 0
    s_cbranch_scc1 L_FIN
    s_branch L_FIN2
L_respinDVb:
    ds_read_b32 v15, v6 offset:4
    s_waitcnt lgkmcnt(0)
    v_readfirstlane_b32 s80, v15
    s_branch L_spinDVb
L_respinDLb:
    ds_read_b32 v15, v6 offset:4
    s_waitcnt lgkmcnt(0)
    v_readfirstlane_b32 s80, v15
    s_branch L_spinDLb
L_respinDVa:
    ds_read_b32 v15, v6 offset:4
    s_waitcnt lgkmcnt(0)
    v_readfirstlane_b32 s80, v15
    s_branch L_spinDVa
L_HANDLER:
    s_setprio 3
    s_add_u32 s22, s22, 8
    s_addc_u32 s23, s23, 0
    s_lshl_b32 s82, s45, 1
    s_add_u32 s82, s82, s46
    s_and_b32 s83, s44, 1
    s_lshl_b32 s84, s83, 11
    s_lshl_b32 s85, s82, 14
    s_add_u32 s85, s85, s84
    s_cmp_eq_u32 s3, 2
    s_cbranch_scc1 L_H2
    s_cmp_eq_u32 s3, 3
    s_cbranch_scc1 L_H3
    s_cmp_eq_u32 s3, 4
    s_cbranch_scc1 L_H4
    s_cmp_eq_u32 s3, 5
    s_cbranch_scc1 L_H5
    v_add_u32 v16, s84, v0
    ds_read_b32 v17, v6
    ds_read_b128 v[84:87], v16 offset:16384
    ds_read_b128 v[88:91], v16 offset:17408
    ds_read_b128 v[92:95], v16 offset:20480
    ds_read_b128 v[96:99], v16 offset:21504
    ds_read_b128 v[236:239], v16 offset:24576
    ds_read_b128 v[240:243], v16 offset:25600
    ds_read_b128 v[244:247], v16 offset:28672
    ds_read_b128 v[248:251], v16 offset:29696
    s_waitcnt lgkmcnt(0)
    v_readfirstlane_b32 s80, v17
    v_mov_b32_e64 v17, 1
    s_nop 2
    s_cmp_eq_u32 s80, 4
    s_cbranch_scc0 L_HRET
    s_mov_b64 exec, 1
    ds_add_u32 v0, v17 offset:4
    s_mov_b64 exec, -1
    s_lshl_b32 s80, s47, 12
    s_add_u32 s80, s80, s85
    s_nop 0
    v_pk_add_f32 v[84:85], v[84:85], v[92:93]
    v_pk_add_f32 v[86:87], v[86:87], v[94:95]
    v_pk_add_f32 v[88:89], v[88:89], v[96:97]
    v_pk_add_f32 v[90:91], v[90:91], v[98:99]
    v_pk_add_f32 v[236:237], v[236:237], v[244:245]
    v_pk_add_f32 v[238:239], v[238:239], v[246:247]
    v_pk_add_f32 v[240:241], v[240:241], v[248:249]
    v_pk_add_f32 v[242:243], v[242:243], v[250:251]
    v_pk_add_f32 v[84:85], v[84:85], v[236:237]
    v_pk_add_f32 v[86:87], v[86:87], v[238:239]
    v_pk_add_f32 v[88:89], v[88:89], v[240:241]
    v_pk_add_f32 v[90:91], v[90:91], v[242:243]
    buffer_store_dwordx4 v[84:87], v0, s[40:43], s80 offen offset:0 sc1
    buffer_store_dwordx4 v[88:91], v0, s[40:43], s80 offen offset:1024 sc1
    s_mov_b32 s3, 2
L_HRET:
    s_setprio 0
    s_setpc_b64 s[22:23]
L_H2:
    v_mov_b32_e64 v17, 1
    s_lshl_b32 s81, s82, 2
    s_mov_b32 s21, 1
    s_mov_b32 s3, 5
    s_waitcnt vmcnt(0)
    s_mov_b64 exec, 1
    ds_add_rtn_u32 v17, v0, v17 offset:8
    s_waitcnt lgkmcnt(0)
    s_mov_b64 exec, -1
    v_readfirstlane_b32 s80, v17
    s_nop 3
    s_cmp_eq_u32 s80, 1
    s_cbranch_scc0 L_WARM
    s_atomic_add s21, s[16:17], s81 glc
    s_mov_b32 s3, 3
    s_setprio 0
    s_setpc_b64 s[22:23]
L_H5:
    ds_read_b32 v17, v6 offset:12
    s_waitcnt lgkmcnt(0)
    v_readfirstlane_b32 s21, v17
    s_nop 3
    s_cmp_eq_u32 s21, 0
    s_cbranch_scc1 L_HRET
    s_branch L_H3b
L_WARM:
    s_mov_b64 exec, 0
    s_branch L_EPI
L_WARM2:
    s_mov_b64 exec, -1
    s_branch L_HRET
L_H3:
    s_waitcnt lgkmcnt(0)
    s_add_u32 s21, s21, 1
    v_mov_b32 v17, s21
    ds_write_b32 v6, v17 offset:12
L_H3b:
    s_mov_b32 s3, 0
    s_cmp_eq_u32 s21, 4
    s_cbranch_scc0 L_HRET
    s_nop 0
    buffer_load_dwordx4 v[84:87], v0, s[40:43], s85 offen offset:0 sc1
    buffer_load_dwordx4 v[88:91], v0, s[40:43], s85 offen offset:1024 sc1
    s_add_u32 s85, s85, 4096
    buffer_load_dwordx4 v[92:95], v0, s[40:43], s85 offen offset:0 sc1
    buffer_load_dwordx4 v[96:99], v0, s[40:43], s85 offen offset:1024 sc1
    s_add_u32 s85, s85, 4096
    buffer_load_dwordx4 v[236:239], v0, s[40:43], s85 offen offset:0 sc1
    buffer_load_dwordx4 v[240:243], v0, s[40:43], s85 offen offset:1024 sc1
    s_add_u32 s85, s85, 4096
    buffer_load_dwordx4 v[244:247], v0, s[40:43], s85 offen offset:0 sc1
    buffer_load_dwordx4 v[248:251], v0, s[40:43], s85 offen offset:1024 sc1
    s_add_u32 s85, s85, 4096
    s_mov_b32 s3, 4
    s_setprio 0
    s_setpc_b64 s[22:23]
L_H4:
    s_mul_i32 s80, s45, 36864
    s_mul_i32 s81, s46, 576
    s_add_u32 s80, s80, s81
    s_lshl_b32 s81, s83, 5
    s_add_u32 s80, s80, s81
    s_waitcnt vmcnt(0)
    s_nop 0
    v_pk_add_f32 v[84:85], v[84:85], v[92:93]
    v_pk_add_f32 v[86:87], v[86:87], v[94:95]
    v_pk_add_f32 v[88:89], v[88:89], v[96:97]
    v_pk_add_f32 v[90:91], v[90:91], v[98:99]
    v_pk_add_f32 v[236:237], v[236:237], v[244:245]
    v_pk_add_f32 v[238:239], v[238:239], v[246:247]
    v_pk_add_f32 v[240:241], v[240:241], v[248:249]
    v_pk_add_f32 v[242:243], v[242:243], v[250:251]
    v_pk_add_f32 v[84:85], v[84:85], v[236:237]
    v_pk_add_f32 v[86:87], v[86:87], v[238:239]
    v_pk_add_f32 v[88:89], v[88:89], v[240:241]
    v_pk_add_f32 v[90:91], v[90:91], v[242:243]
    v_lshlrev_b32_e64 v96, 16, v20
    v_pk_mul_f32 v[84:85], v[84:85], s[66:67]
    v_pk_mul_f32 v[86:87], v[86:87], s[66:67]
    v_cvt_pk_bf16_f32 v92, v84, v85
    v_cvt_pk_bf16_f32 v93, v86, v87
    v_lshlrev_b32_e64 v84, 16, v92
    v_and_b32 v85, 0xffff0000, v92
    v_lshlrev_b32_e64 v86, 16, v93
    v_and_b32 v87, 0xffff0000, v93
    v_pk_add_f32 v[84:85], v[84:85], v[96:97] op_sel_hi:[1,0]
    v_pk_add_f32 v[86:87], v[86:87], v[96:97] op_sel_hi:[1,0]
    v_cvt_pk_bf16_f32 v84, v84, v85
    v_cvt_pk_bf16_f32 v85, v86, v87
    buffer_store_dwordx2 v[84:85], v145, s[36:39], s80 offen offset:512
    v_and_b32 v96, 0xffff0000, v20
    v_pk_mul_f32 v[88:89], v[88:89], s[66:67]
    v_pk_mul_f32 v[90:91], v[90:91], s[66:67]
    v_cvt_pk_bf16_f32 v92, v88, v89
    v_cvt_pk_bf16_f32 v93, v90, v91
    v_lshlrev_b32_e64 v88, 16, v92
    v_and_b32 v89, 0xffff0000, v92
    v_lshlrev_b32_e64 v90, 16, v93
    v_and_b32 v91, 0xffff0000, v93
    v_pk_add_f32 v[88:89], v[88:89], v[96:97] op_sel_hi:[1,0]
    v_pk_add_f32 v[90:91], v[90:91], v[96:97] op_sel_hi:[1,0]
    v_cvt_pk_bf16_f32 v88, v88, v89
    v_cvt_pk_bf16_f32 v89, v90, v91
    buffer_store_dwordx2 v[88:89], v145, s[36:39], s80 offen offset:1664
    s_mov_b32 s3, 0
    s_setprio 0
    s_setpc_b64 s[22:23]
.p2align 6
L_PV1:
    s_mov_b32 s26, 0x409d30fc
    s_mov_b32 s66, 0x40361376
    s_mov_b32 s28, 0x3faaaaab
    s_mov_b32 s30, 0x05040100
    s_mov_b32 s31, 0x07060302
L_pad1_2:
    s_cbranch_execz L_ret1
    s_mov_b32 s29, s28
    s_mov_b32 s27, s26
    s_mov_b32 s67, s66
    s_mov_b32 s3, 0
    v_lshrrev_b32 v255, 4, v253
    v_and_b32 v254, 15, v253
    v_lshlrev_b32 v3, 2, v254
    v_mul_u32_u24 v1, 73728, v255
    v_and_b32_e64 v252, 1, v255
    v_lshl_add_u32 v2, v252, 10, v3
    v_and_b32_e64 v252, 32, v253
    v_lshl_add_u32 v2, v252, 1, v2
    v_and_b32_e64 v16, 12, v253
    v_add_lshl_u32 v16, v16, v255, 2
    v_mov_b32 v7, 0xdddddddd
    s_mov_b32 s64, 0x3faa2fe7
    s_mov_b32 s65, s64
    v_add_u32 v1, v1, v3
    s_bitcmp1_b32 s44, 1
    s_cselect_b32 s21, 48, 44
    s_cselect_b32 s20, 12, 64
    s_add_u32 s24, s44, s21
    s_add_u32 s20, s20, s24
    s_add_u32 s81, s44, 64
    s_mul_i32 s25, s47, 18
    s_add_u32 s25, s25, s81
    s_cmp_ge_u32 s25, 72
    s_cselect_b32 s80, 72, 0
    s_sub_u32 s25, s25, s80
    s_lshl_b32 s80, s25, 7
    s_lshl_b32 s81, s80, 5
    v_add_u32 v1, s80, v1
    v_add_u32 v2, s81, v2
    v_mov_b32 v6, 0
    v_mov_b32 v205, 0
    v_mov_b32 v206, 0
    v_mov_b32 v209, 0
    v_mov_b32 v210, 0
    v_mov_b32 v212, 0
    v_mov_b32 v213, 0
    v_mov_b32 v214, 0
    v_mov_b32 v215, 0
    v_mov_b32 v216, 0
    v_mov_b32 v217, 0
    v_mov_b32 v218, 0
    v_mov_b32 v219, 0
    v_mov_b32 v204, 0x3ef0
    v_mfma_f32_32x32x8_bf16 v[52:67], v[212:213], v[212:213], 0
    v_mov_b32 v207, v204
    v_lshlrev_b32 v208, 16, v204
    v_lshlrev_b32 v211, 16, v204
    v_and_b32 v252, 3, v253
    v_lshrrev_b32_e64 v17, 2, v254
    v_lshl_add_u32 v17, v255, 3, v17
    v_mfma_f32_32x32x8_bf16 v[68:83], v[212:213], v[212:213], 0
    v_mul_u32_u24 v17, 320, v17
    v_lshl_add_u32 v17, v252, 3, v17
    v_lshl_add_u32 v17, v255, 5, v17
    v_add_u32 v146, 64, v17
    v_add_u32 v147, 0, v17
    s_lshl_b32 s81, s44, 13
    v_add_u32 v11, s81, v0
    v_mul_u32_u24 v145, 576, v16
    v_lshl_add_u32 v145, v252, 3, v145
    s_waitcnt lgkmcnt(0)
    s_mul_i32 s1, s45, 36864
    s_mul_i32 s81, s46, 576
    s_add_u32 s1, s1, s81
    s_lshl_b32 s81, s47, 3
    s_add_u32 s81, s81, s44
    s_lshl_b32 s81, s81, 4
    s_add_u32 s1, s1, s81
    s_and_b32 s81, s44, 1
    s_mul_i32 s81, s81, 1136
    s_add_u32 s1, s1, s81
    s_mov_b32 s32, s8
    s_mov_b32 s33, s9
    s_mov_b32 s34, 9216
    s_mov_b32 s35, 0x00020000
    s_mov_b32 s36, s14
    s_mov_b32 s37, s15
    s_mov_b32 s38, 1179648
    s_mov_b32 s39, 0x00020000
    s_mov_b32 s40, s18
    s_mov_b32 s41, s19
    s_mov_b32 s42, 1048576
    s_mov_b32 s43, 0x00020000
    s_movk_i32 s80, 9216
    s_mov_b64 s[48:49], s[6:7]
    s_add_u32 s50, s48, s80
    s_addc_u32 s51, s49, 0
    s_add_u32 s52, s50, s80
    s_addc_u32 s53, s51, 0
    s_add_u32 s54, s52, s80
    s_addc_u32 s55, s53, 0
    s_add_u32 s56, s54, s80
    s_addc_u32 s57, s55, 0
    s_add_u32 s58, s56, s80
    s_addc_u32 s59, s57, 0
    s_add_u32 s60, s58, s80
    s_addc_u32 s61, s59, 0
    s_add_u32 s62, s60, s80
    s_addc_u32 s63, s61, 0
    global_load_dwordx4 v[116:119], v12, s[84:85] offset:0
    global_load_dwordx4 v[120:123], v12, s[84:85] offset:256
    global_load_dwordx4 v[124:127], v12, s[84:85] offset:512
    global_load_dwordx4 v[128:131], v12, s[84:85] offset:768
    global_load_dwordx2 v[134:135], v14, s[84:85] offset:1024
    global_load_dwordx4 v[140:143], v13, s[84:85]
    v_lshlrev_b32_e64 v255, 19, v253
    s_add_u32 s87, s44, 25
    s_lshl_b32 s88, s87, 25
    s_or_b32 s88, s88, 0x8000
    s_lshl_b32 s94, s87, 10
    s_mov_b32 s89, 0x10000
    s_mov_b32 s95, 0x3f803f80
    v_add_u32 v252, s94, v0
    v_add_u32 v84, s88, v255
    v_add_u32 v85, s89, v84
    v_add_u32 v86, s89, v85
    v_add_u32 v87, s89, v86
    v_add_u32 v88, s89, v87
    v_add_u32 v89, s89, v88
    v_add_u32 v90, s89, v89
    v_add_u32 v91, s89, v90
    v_add_u32_e64 v254, s89, v252
    v_pk_fma_f32 v[28:29], v[84:85], v[84:85], s[26:27]
    v_pk_fma_f32 v[30:31], v[86:87], v[86:87], s[26:27]
    v_pk_fma_f32 v[32:33], v[88:89], v[88:89], s[26:27]
    v_pk_fma_f32 v[34:35], v[90:91], v[90:91], s[26:27]
    v_pk_mul_f32 v[28:29], v[28:29], v[84:85] neg_lo:[0,1] neg_hi:[0,1]
    v_pk_mul_f32 v[30:31], v[30:31], v[86:87] neg_lo:[0,1] neg_hi:[0,1]
    v_pk_mul_f32 v[32:33], v[32:33], v[88:89] neg_lo:[0,1] neg_hi:[0,1]
    v_pk_mul_f32 v[34:35], v[34:35], v[90:91] neg_lo:[0,1] neg_hi:[0,1]
    v_exp_f32 v28, v28
    v_exp_f32 v29, v29
    v_exp_f32 v30, v30
    v_exp_f32 v31, v31
    v_exp_f32 v32, v32
    v_exp_f32 v33, v33
    v_exp_f32 v34, v34
    v_exp_f32 v35, v35
    v_pk_fma_f32 v[92:93], v[28:29], s[28:29], s[28:29]
    v_pk_fma_f32 v[94:95], v[30:31], s[28:29], s[28:29]
    v_pk_fma_f32 v[96:97], v[32:33], s[28:29], s[28:29]
    v_pk_fma_f32 v[98:99], v[34:35], s[28:29], s[28:29]
    v_rcp_f32 v92, v92
    v_rcp_f32 v93, v93
    v_rcp_f32 v94, v94
    v_rcp_f32 v95, v95
    v_rcp_f32 v96, v96
    v_rcp_f32 v97, v97
    v_rcp_f32 v98, v98
    v_rcp_f32 v99, v99
    v_pk_mul_f32 v[92:93], v[92:93], v[84:85]
    v_pk_mul_f32 v[94:95], v[94:95], v[86:87]
    v_pk_mul_f32 v[96:97], v[96:97], v[88:89]
    v_pk_mul_f32 v[98:99], v[98:99], v[90:91]
    v_pk_mul_f32 v[28:29], v[28:29], v[92:93]
    v_pk_mul_f32 v[30:31], v[30:31], v[94:95]
    v_pk_mul_f32 v[32:33], v[32:33], v[96:97]
    v_pk_mul_f32 v[34:35], v[34:35], v[98:99]
    v_cvt_pk_bf16_f32 v36, v92, v93
    v_cvt_pk_bf16_f32 v37, v94, v95
    v_cvt_pk_bf16_f32 v38, v96, v97
    v_cvt_pk_bf16_f32 v39, v98, v99
    v_cvt_pk_bf16_f32 v40, -v28, -v29
    v_cvt_pk_bf16_f32 v41, -v30, -v31
    v_cvt_pk_bf16_f32 v42, -v32, -v33
    v_cvt_pk_bf16_f32 v43, -v34, -v35
    ds_write_b128 v252, v[36:39] offset:64512
    ds_write_b128 v254, v[40:43] offset:64512
    global_load_dword v148, v1, s[48:49] offset:0
    global_load_dword v156, v1, s[48:49] offset:64
    global_load_dword v149, v1, s[50:51] offset:0
    global_load_dword v157, v1, s[50:51] offset:64
    global_load_dword v150, v1, s[52:53] offset:0
    global_load_dword v158, v1, s[52:53] offset:64
    global_load_dword v151, v1, s[54:55] offset:0
    global_load_dword v159, v1, s[54:55] offset:64
    global_load_dword v152, v1, s[56:57] offset:0
    global_load_dword v160, v1, s[56:57] offset:64
L_pad1_3:
    s_cbranch_execz L_ret1
    s_nop 0
    global_load_dword v153, v1, s[58:59] offset:0
    global_load_dword v161, v1, s[58:59] offset:64
    global_load_dword v154, v1, s[60:61] offset:0
    global_load_dword v162, v1, s[60:61] offset:64
    global_load_dword v155, v1, s[62:63] offset:0
    global_load_dword v163, v1, s[62:63] offset:64
    buffer_load_dword v4, v1, s[32:35], 0 offen offset:0
    buffer_load_dword v5, v1, s[32:35], 0 offen offset:64
    s_mov_b32 s90, 0xffff0000
    s_mov_b32 s91, 0x3ae38e39
    s_mov_b32 s92, 0x3727c5ac
    v_mov_b32 v240, 0
    v_mov_b32 v241, 0
    s_waitcnt vmcnt(29)
    v_dot2c_f32_bf16 v240, s95, v100
    v_dot2c_f32_bf16 v241, v100, v100
    v_dot2c_f32_bf16 v240, s95, v101
    v_dot2c_f32_bf16 v241, v101, v101
    v_dot2c_f32_bf16 v240, s95, v102
    v_dot2c_f32_bf16 v241, v102, v102
    v_dot2c_f32_bf16 v240, s95, v103
    v_dot2c_f32_bf16 v241, v103, v103
    s_waitcnt vmcnt(28)
    v_dot2c_f32_bf16 v240, s95, v104
    v_dot2c_f32_bf16 v241, v104, v104
    v_dot2c_f32_bf16 v240, s95, v105
    v_dot2c_f32_bf16 v241, v105, v105
    v_dot2c_f32_bf16 v240, s95, v106
    v_dot2c_f32_bf16 v241, v106, v106
    v_dot2c_f32_bf16 v240, s95, v107
    v_dot2c_f32_bf16 v241, v107, v107
    s_waitcnt vmcnt(27)
    v_dot2c_f32_bf16 v240, s95, v108
    v_dot2c_f32_bf16 v241, v108, v108
    v_dot2c_f32_bf16 v240, s95, v109
    v_dot2c_f32_bf16 v241, v109, v109
    v_dot2c_f32_bf16 v240, s95, v110
    v_dot2c_f32_bf16 v241, v110, v110
    v_dot2c_f32_bf16 v240, s95, v111
    v_dot2c_f32_bf16 v241, v111, v111
    s_waitcnt vmcnt(26)
    v_dot2c_f32_bf16 v240, s95, v112
    v_dot2c_f32_bf16 v241, v112, v112
    v_dot2c_f32_bf16 v240, s95, v113
    v_dot2c_f32_bf16 v241, v113, v113
    v_dot2c_f32_bf16 v240, s95, v114
    v_dot2c_f32_bf16 v241, v114, v114
    v_dot2c_f32_bf16 v240, s95, v115
    v_dot2c_f32_bf16 v241, v115, v115
    s_waitcnt vmcnt(25)
    v_dot2c_f32_bf16 v240, s95, v132
    v_dot2c_f32_bf16 v241, v132, v132
    v_dot2c_f32_bf16 v240, s95, v133
    v_dot2c_f32_bf16 v241, v133, v133
    v_mov_b32 v244, 0
    v_mov_b32_e64 v245, 0
    s_waitcnt vmcnt(23)
    v_dot2c_f32_bf16 v244, s95, v116
    v_dot2c_f32_bf16 v245, v116, v116
    v_dot2c_f32_bf16 v244, s95, v117
    v_dot2c_f32_bf16 v245, v117, v117
    v_dot2c_f32_bf16 v244, s95, v118
    v_dot2c_f32_bf16 v245, v118, v118
    v_dot2c_f32_bf16 v244, s95, v119
    v_dot2c_f32_bf16 v245, v119, v119
    s_waitcnt vmcnt(22)
    v_dot2c_f32_bf16 v244, s95, v120
    v_dot2c_f32_bf16 v245, v120, v120
    v_dot2c_f32_bf16 v244, s95, v121
    v_dot2c_f32_bf16 v245, v121, v121
    v_dot2c_f32_bf16 v244, s95, v122
    v_dot2c_f32_bf16 v245, v122, v122
    v_dot2c_f32_bf16 v244, s95, v123
    v_dot2c_f32_bf16 v245, v123, v123
    s_waitcnt vmcnt(21)
    v_dot2c_f32_bf16 v244, s95, v124
    v_dot2c_f32_bf16 v245, v124, v124
    v_dot2c_f32_bf16 v244, s95, v125
    v_dot2c_f32_bf16 v245, v125, v125
    v_dot2c_f32_bf16 v244, s95, v126
    v_dot2c_f32_bf16 v245, v126, v126
    v_dot2c_f32_bf16 v244, s95, v127
    v_dot2c_f32_bf16 v245, v127, v127
    s_waitcnt vmcnt(20)
    v_dot2c_f32_bf16 v244, s95, v128
    v_dot2c_f32_bf16 v245, v128, v128
    v_dot2c_f32_bf16 v244, s95, v129
    v_dot2c_f32_bf16 v245, v129, v129
    v_dot2c_f32_bf16 v244, s95, v130
    v_dot2c_f32_bf16 v245, v130, v130
    v_dot2c_f32_bf16 v244, s95, v131
    v_dot2c_f32_bf16 v245, v131, v131
    s_waitcnt vmcnt(19)
    v_dot2c_f32_bf16 v244, s95, v134
    v_dot2c_f32_bf16 v245, v134, v134
    v_dot2c_f32_bf16 v244, s95, v135
    v_dot2c_f32_bf16 v245, v135, v135
    s_nop 2
L_PV2:
    v_add_f32_dpp v240, v240, v240 row_ror:8 row_mask:0xf bank_mask:0xf
    v_add_f32_dpp v244, v244, v244 row_ror:8 row_mask:0xf bank_mask:0xf
    v_add_f32_dpp v241, v241, v241 row_ror:8 row_mask:0xf bank_mask:0xf
    v_add_f32_dpp v245, v245, v245 row_ror:8 row_mask:0xf bank_mask:0xf
    v_add_f32_dpp v240, v240, v240 row_ror:4 row_mask:0xf bank_mask:0xf
    v_add_f32_dpp v244, v244, v244 row_ror:4 row_mask:0xf bank_mask:0xf
    v_add_f32_dpp v241, v241, v241 row_ror:4 row_mask:0xf bank_mask:0xf
    v_add_f32_dpp v245, v245, v245 row_ror:4 row_mask:0xf bank_mask:0xf
    v_add_f32_dpp v240, v240, v240 row_ror:2 row_mask:0xf bank_mask:0xf
    v_add_f32_dpp v244, v244, v244 row_ror:2 row_mask:0xf bank_mask:0xf
    v_add_f32_dpp v241, v241, v241 row_ror:2 row_mask:0xf bank_mask:0xf
    v_add_f32_dpp v245, v245, v245 row_ror:2 row_mask:0xf bank_mask:0xf
    v_add_f32_dpp v240, v240, v240 row_ror:1 row_mask:0xf bank_mask:0xf
    v_add_f32_dpp v244, v244, v244 row_ror:1 row_mask:0xf bank_mask:0xf
    v_add_f32_dpp v241, v241, v241 row_ror:1 row_mask:0xf bank_mask:0xf
    v_add_f32_dpp v245, v245, v245 row_ror:1 row_mask:0xf bank_mask:0xf
    v_mul_f32 v240, s91, v240
    v_mul_f32 v244, s91, v244
    v_mul_f32 v241, s91, v241
    v_mul_f32 v245, s91, v245
    v_fma_f32 v241, -v240, v240, v241
    v_fma_f32 v245, -v244, v244, v245
    v_max_f32 v241, 0, v241
    v_max_f32 v245, 0, v245
    v_cvt_pk_bf16_f32 v242, v240, v241
    v_cvt_pk_bf16_f32 v246, v244, v245
    v_and_b32 v241, s90, v242
    v_and_b32 v245, s90, v246
    v_lshlrev_b32 v240, 16, v242
    v_lshlrev_b32 v244, 16, v246
    v_add_f32 v241, s92, v241
    v_add_f32 v245, s92, v245
    v_cvt_pk_bf16_f32 v242, v241, v241
    v_cvt_pk_bf16_f32 v246, v245, v245
    v_lshlrev_b32 v241, 16, v242
    v_lshlrev_b32 v245, 16, v246
    v_sqrt_f32 v241, v241
    v_sqrt_f32 v245, v245
    v_lshlrev_b32 v100, 16, v136
    s_waitcnt vmcnt(18)
    v_lshlrev_b32 v116, 16, v140
    v_and_b32 v101, s90, v136
    v_and_b32 v117, s90, v140
    v_lshlrev_b32 v102, 16, v137
    v_lshlrev_b32 v118, 16, v141
    v_and_b32 v103, s90, v137
    v_and_b32 v119, s90, v141
    v_lshlrev_b32 v104, 16, v138
    v_lshlrev_b32 v120, 16, v142
    v_and_b32 v105, s90, v138
    v_and_b32 v121, s90, v142
    v_lshlrev_b32 v106, 16, v139
    v_lshlrev_b32 v122, 16, v143
    v_and_b32 v107, s90, v139
    v_and_b32_e64 v123, s90, v143
    v_pk_add_f32 v[100:101], v[100:101], v[240:241] op_sel_hi:[1,0] neg_lo:[0,1] neg_hi:[0,1]
    v_pk_add_f32 v[116:117], v[116:117], v[244:245] op_sel_hi:[1,0] neg_lo:[0,1] neg_hi:[0,1]
    v_pk_add_f32 v[102:103], v[102:103], v[240:241] op_sel_hi:[1,0] neg_lo:[0,1] neg_hi:[0,1]
    v_pk_add_f32 v[118:119], v[118:119], v[244:245] op_sel_hi:[1,0] neg_lo:[0,1] neg_hi:[0,1]
    v_pk_add_f32 v[104:105], v[104:105], v[240:241] op_sel_hi:[1,0] neg_lo:[0,1] neg_hi:[0,1]
    v_pk_add_f32 v[120:121], v[120:121], v[244:245] op_sel_hi:[1,0] neg_lo:[0,1] neg_hi:[0,1]
    v_pk_add_f32 v[106:107], v[106:107], v[240:241] op_sel_hi:[1,0] neg_lo:[0,1] neg_hi:[0,1]
    v_pk_add_f32 v[122:123], v[122:123], v[244:245] op_sel_hi:[1,0] neg_lo:[0,1] neg_hi:[0,1]
    v_cvt_pk_bf16_f32 v242, v241, v241
    v_cvt_pk_bf16_f32 v246, v245, v245
    v_lshlrev_b32 v241, 16, v242
    v_lshlrev_b32 v245, 16, v246
    v_rcp_f32 v241, v241
    v_rcp_f32 v245, v245
    v_cvt_pk_bf16_f32 v136, v100, v101
    v_cvt_pk_bf16_f32 v140, v116, v117
    v_cvt_pk_bf16_f32 v137, v102, v103
    v_cvt_pk_bf16_f32 v141, v118, v119
    v_cvt_pk_bf16_f32 v138, v104, v105
    v_cvt_pk_bf16_f32 v142, v120, v121
    v_cvt_pk_bf16_f32 v139, v106, v107
    v_cvt_pk_bf16_f32 v143, v122, v123
    v_mul_f32 v241, 0x3eeff558, v241
    v_mul_f32 v245, 0x3eeff558, v245
    v_lshlrev_b32 v100, 16, v136
    v_lshlrev_b32 v116, 16, v140
    v_and_b32 v101, s90, v136
    v_and_b32 v117, s90, v140
    v_lshlrev_b32 v102, 16, v137
    v_lshlrev_b32 v118, 16, v141
    v_and_b32 v103, s90, v137
    v_and_b32 v119, s90, v141
    v_lshlrev_b32 v104, 16, v138
    v_lshlrev_b32 v120, 16, v142
    v_and_b32 v105, s90, v138
    v_and_b32 v121, s90, v142
    v_lshlrev_b32 v106, 16, v139
    v_lshlrev_b32 v122, 16, v143
    v_and_b32 v107, s90, v139
    v_and_b32 v123, s90, v143
    v_pk_mul_f32 v[100:101], v[100:101], v[240:241] op_sel:[0,1] op_sel_hi:[1,1]
    v_pk_mul_f32 v[116:117], v[116:117], v[244:245] op_sel:[0,1] op_sel_hi:[1,1]
    v_pk_mul_f32 v[102:103], v[102:103], v[240:241] op_sel:[0,1] op_sel_hi:[1,1]
    v_pk_mul_f32 v[118:119], v[118:119], v[244:245] op_sel:[0,1] op_sel_hi:[1,1]
    v_pk_mul_f32 v[104:105], v[104:105], v[240:241] op_sel:[0,1] op_sel_hi:[1,1]
    v_pk_mul_f32 v[120:121], v[120:121], v[244:245] op_sel:[0,1] op_sel_hi:[1,1]
    v_pk_mul_f32 v[106:107], v[106:107], v[240:241] op_sel:[0,1] op_sel_hi:[1,1]
    v_pk_mul_f32 v[122:123], v[122:123], v[244:245] op_sel:[0,1] op_sel_hi:[1,1]
    v_cvt_pk_bf16_f32 v136, v100, v101
    v_cvt_pk_bf16_f32 v140, v116, v117
    v_cvt_pk_bf16_f32 v137, v102, v103
    v_cvt_pk_bf16_f32 v141, v118, v119
    v_cvt_pk_bf16_f32 v138, v104, v105
    v_cvt_pk_bf16_f32 v142, v120, v121
    v_cvt_pk_bf16_f32 v139, v106, v107
    v_cvt_pk_bf16_f32 v143, v122, v123
    ds_write_b128 v15, v[136:139] offset:1024
    ds_write_b128 v18, v[140:143] offset:1024
    s_setprio 0
    s_waitcnt vmcnt(0)
    s_branch L_JOIN
L_V22pre:
    s_nop 0
    global_load_dword v180, v2, s[10:11] offset:0
    global_load_dword v181, v2, s[10:11] offset:128
    global_load_dword v182, v2, s[10:11] offset:256
    global_load_dword v183, v2, s[10:11] offset:384
    global_load_dword v184, v2, s[10:11] offset:512
    global_load_dword v185, v2, s[10:11] offset:640
    global_load_dword v186, v2, s[10:11] offset:768
    global_load_dword v187, v2, s[10:11] offset:896
    global_load_dword v196, v2, s[10:11] offset:2048
    global_load_dword v197, v2, s[10:11] offset:2176
    global_load_dword v198, v2, s[10:11] offset:2304
    global_load_dword v199, v2, s[10:11] offset:2432
    global_load_dword v200, v2, s[10:11] offset:2560
    global_load_dword v201, v2, s[10:11] offset:2688
    global_load_dword v202, v2, s[10:11] offset:2816
    global_load_dword v203, v2, s[10:11] offset:2944
    global_load_dword v20, v16, s[12:13]
    s_waitcnt lgkmcnt(6)
    v_mfma_f32_16x16x32_bf16 v[100:103], v[172:175], v[28:31], v[132:135]
    v_mfma_f32_16x16x32_bf16 v[104:107], v[176:179], v[28:31], v[136:139]
    s_waitcnt lgkmcnt(4)
    v_mfma_f32_16x16x32_bf16 v[108:111], v[172:175], v[32:35], v[132:135]
    v_mfma_f32_16x16x32_bf16 v[112:115], v[176:179], v[32:35], v[136:139]
    s_waitcnt lgkmcnt(0)
    s_setprio 0
    v_mov_b32 v15, 1
    s_mov_b64 exec, 1
    ds_add_u32 v6, v15 offset:4
    s_mov_b64 exec, -1
.p2align 3
L_V22:
    s_cmp_lt_u32 s25, 4
    s_cselect_b32 s80, 68, -4
    s_add_u32 s25, s25, s80
    s_lshl_b32 s80, s80, 7
    s_lshl_b32 s81, s80, 5
    v_add_u32 v1, s80, v1
    v_add_u32 v2, s81, v2
    v_pk_fma_f32 v[220:221], v[100:101], v[100:101], s[26:27]
    v_pk_fma_f32 v[222:223], v[102:103], v[102:103], s[26:27]
    v_pk_fma_f32 v[224:225], v[104:105], v[104:105], s[26:27]
    v_pk_fma_f32 v[226:227], v[106:107], v[106:107], s[26:27]
    v_pk_fma_f32 v[228:229], v[108:109], v[108:109], s[26:27]
    v_pk_fma_f32 v[230:231], v[110:111], v[110:111], s[26:27]
    v_pk_fma_f32 v[232:233], v[112:113], v[112:113], s[26:27]
    v_pk_fma_f32 v[234:235], v[114:115], v[114:115], s[26:27]
    v_pk_mul_f32 v[220:221], v[220:221], v[100:101] neg_lo:[0,1] neg_hi:[0,1]
    v_pk_mul_f32 v[222:223], v[222:223], v[102:103] neg_lo:[0,1] neg_hi:[0,1]
    v_pk_mul_f32 v[224:225], v[224:225], v[104:105] neg_lo:[0,1] neg_hi:[0,1]
    v_pk_mul_f32 v[226:227], v[226:227], v[106:107] neg_lo:[0,1] neg_hi:[0,1]
    v_pk_mul_f32 v[228:229], v[228:229], v[108:109] neg_lo:[0,1] neg_hi:[0,1]
    v_pk_mul_f32 v[230:231], v[230:231], v[110:111] neg_lo:[0,1] neg_hi:[0,1]
    v_pk_mul_f32 v[232:233], v[232:233], v[112:113] neg_lo:[0,1] neg_hi:[0,1]
    v_pk_mul_f32 v[234:235], v[234:235], v[114:115] neg_lo:[0,1] neg_hi:[0,1]
    v_smfmac_f32_16x16x64_bf16 v[68:71], v[212:215], v[116:123], v7
    v_exp_f32_e64 v220, v220
    v_smfmac_f32_16x16x64_bf16 v[72:75], v[216:219], v[116:123], v7
    v_exp_f32_e64 v221, v221
    v_smfmac_f32_16x16x64_bf16 v[76:79], v[212:215], v[124:131], v7
    v_exp_f32_e64 v222, v222
    v_smfmac_f32_16x16x64_bf16 v[80:83], v[216:219], v[124:131], v7
    v_exp_f32_e64 v223, v223
    v_mfma_f32_16x16x32_bf16 v[116:119], v[172:175], v[36:39], v[132:135]
    v_exp_f32_e64 v224, v224
    v_mfma_f32_16x16x32_bf16 v[120:123], v[176:179], v[36:39], v[136:139]
    v_exp_f32_e64 v225, v225
    v_mfma_f32_16x16x32_bf16 v[124:127], v[172:175], v[40:43], v[132:135]
    v_exp_f32_e64 v226, v226
    v_mfma_f32_16x16x32_bf16 v[128:131], v[176:179], v[40:43], v[136:139]
    v_exp_f32 v227, v227
    v_exp_f32 v228, v228
    v_exp_f32 v229, v229
    v_exp_f32 v230, v230
    v_exp_f32 v231, v231
    v_exp_f32 v232, v232
    v_exp_f32 v233, v233
    v_exp_f32 v234, v234
    v_exp_f32 v235, v235
    s_waitcnt vmcnt(0)
    v_perm_b32 v188, v181, v180, s30
    v_perm_b32 v189, v183, v182, s30
    v_perm_b32 v190, v185, v184, s30
    v_perm_b32 v191, v187, v186, s30
    v_perm_b32 v192, v181, v180, s31
    v_perm_b32 v193, v183, v182, s31
    v_perm_b32 v194, v185, v184, s31
    v_perm_b32 v195, v187, v186, s31
    v_perm_b32 v164, v157, v156, s30
    v_perm_b32 v165, v159, v158, s30
    v_perm_b32 v166, v161, v160, s30
    v_perm_b32 v167, v163, v162, s30
    v_perm_b32 v168, v157, v156, s31
    v_perm_b32 v169, v159, v158, s31
    v_perm_b32 v170, v161, v160, s31
    v_perm_b32 v171, v163, v162, s31
    v_perm_b32 v212, v197, v196, s30
    v_perm_b32 v213, v199, v198, s30
    v_perm_b32 v214, v201, v200, s30
    v_perm_b32 v215, v203, v202, s30
    v_perm_b32 v216, v197, v196, s31
    v_perm_b32 v217, v199, v198, s31
    v_perm_b32 v218, v201, v200, s31
    v_perm_b32 v219, v203, v202, s31
    s_getpc_b64 s[22:23]
    s_cmp_lg_u32 s3, 0
    s_cbranch_scc1 L_HANDLER
    s_cmp_eq_u32 s24, s20
    s_cselect_b32 s3, 1, s3
    s_nop 0
    global_load_dword v148, v1, s[48:49] offset:0
    global_load_dword v156, v1, s[48:49] offset:64
    global_load_dword v149, v1, s[50:51] offset:0
    global_load_dword v157, v1, s[50:51] offset:64
    global_load_dword v150, v1, s[52:53] offset:0
    global_load_dword v158, v1, s[52:53] offset:64
    global_load_dword v151, v1, s[54:55] offset:0
    global_load_dword v159, v1, s[54:55] offset:64
    global_load_dword v152, v1, s[56:57] offset:0
    global_load_dword v160, v1, s[56:57] offset:64
    global_load_dword v153, v1, s[58:59] offset:0
    global_load_dword v161, v1, s[58:59] offset:64
    global_load_dword v154, v1, s[60:61] offset:0
    global_load_dword v162, v1, s[60:61] offset:64
    global_load_dword v155, v1, s[62:63] offset:0
    global_load_dword v163, v1, s[62:63] offset:64
    v_pk_fma_f32 v[220:221], v[220:221], s[64:65], s[64:65]
    v_pk_fma_f32 v[222:223], v[222:223], s[64:65], s[64:65]
    v_pk_fma_f32 v[224:225], v[224:225], s[64:65], s[64:65]
    v_pk_fma_f32 v[226:227], v[226:227], s[64:65], s[64:65]
    v_pk_fma_f32 v[228:229], v[228:229], s[64:65], s[64:65]
    v_pk_fma_f32 v[230:231], v[230:231], s[64:65], s[64:65]
    v_pk_fma_f32 v[232:233], v[232:233], s[64:65], s[64:65]
    v_pk_fma_f32 v[234:235], v[234:235], s[64:65], s[64:65]
    v_rcp_f32 v220, v220
    v_rcp_f32 v221, v221
    v_rcp_f32 v222, v222
    v_rcp_f32 v223, v223
    v_rcp_f32 v224, v224
    v_rcp_f32 v225, v225
    v_rcp_f32 v226, v226
    v_rcp_f32 v227, v227
    v_rcp_f32 v228, v228
    v_rcp_f32 v229, v229
    v_rcp_f32 v230, v230
    v_rcp_f32 v231, v231
    v_rcp_f32 v232, v232
    v_rcp_f32 v233, v233
    v_rcp_f32 v234, v234
    v_rcp_f32 v235, v235
    v_pk_mul_f32 v[100:101], v[100:101], v[220:221]
    v_pk_mul_f32 v[102:103], v[102:103], v[222:223]
    v_pk_mul_f32 v[104:105], v[104:105], v[224:225]
    v_pk_mul_f32 v[106:107], v[106:107], v[226:227]
    v_pk_mul_f32 v[108:109], v[108:109], v[228:229]
    v_pk_mul_f32 v[110:111], v[110:111], v[230:231]
    v_pk_mul_f32 v[112:113], v[112:113], v[232:233]
    v_pk_mul_f32 v[114:115], v[114:115], v[234:235]
    v_pk_fma_f32 v[220:221], v[116:117], v[116:117], s[26:27]
    v_pk_fma_f32 v[222:223], v[118:119], v[118:119], s[26:27]
    v_pk_fma_f32 v[224:225], v[120:121], v[120:121], s[26:27]
    v_pk_fma_f32 v[226:227], v[122:123], v[122:123], s[26:27]
    v_pk_fma_f32 v[228:229], v[124:125], v[124:125], s[26:27]
    v_pk_fma_f32 v[230:231], v[126:127], v[126:127], s[26:27]
    v_pk_fma_f32 v[232:233], v[128:129], v[128:129], s[26:27]
    v_pk_fma_f32 v[234:235], v[130:131], v[130:131], s[26:27]
    v_pk_mul_f32 v[220:221], v[220:221], v[116:117] neg_lo:[0,1] neg_hi:[0,1]
    v_pk_mul_f32 v[222:223], v[222:223], v[118:119] neg_lo:[0,1] neg_hi:[0,1]
    v_pk_mul_f32 v[224:225], v[224:225], v[120:121] neg_lo:[0,1] neg_hi:[0,1]
    v_pk_mul_f32 v[226:227], v[226:227], v[122:123] neg_lo:[0,1] neg_hi:[0,1]
    v_pk_mul_f32 v[228:229], v[228:229], v[124:125] neg_lo:[0,1] neg_hi:[0,1]
    v_pk_mul_f32 v[230:231], v[230:231], v[126:127] neg_lo:[0,1] neg_hi:[0,1]
    v_pk_mul_f32 v[232:233], v[232:233], v[128:129] neg_lo:[0,1] neg_hi:[0,1]
    v_pk_mul_f32 v[234:235], v[234:235], v[130:131] neg_lo:[0,1] neg_hi:[0,1]
    v_mfma_f32_16x16x16_bf16 v[132:135], v[4:5], v[206:207], 0
    v_exp_f32 v220, v220
    v_exp_f32 v221, v221
    v_mfma_f32_16x16x16_bf16 v[136:139], v[4:5], v[210:211], 0
    v_exp_f32 v222, v222
    v_exp_f32 v223, v223
    v_smfmac_f32_16x16x64_bf16 v[52:55], v[188:191], v[100:107], v7
    v_exp_f32_e64 v224, v224
    v_smfmac_f32_16x16x64_bf16 v[56:59], v[192:195], v[100:107], v7
    v_exp_f32_e64 v225, v225
    v_smfmac_f32_16x16x64_bf16 v[60:63], v[188:191], v[108:115], v7
    v_exp_f32_e64 v226, v226
    v_smfmac_f32_16x16x64_bf16 v[64:67], v[192:195], v[108:115], v7
    v_exp_f32_e64 v227, v227
    v_mfma_f32_16x16x32_bf16 v[100:103], v[164:167], v[28:31], v[132:135]
    v_exp_f32_e64 v228, v228
    v_mfma_f32_16x16x32_bf16 v[104:107], v[168:171], v[28:31], v[136:139]
    v_exp_f32_e64 v229, v229
    v_mfma_f32_16x16x32_bf16 v[108:111], v[164:167], v[32:35], v[132:135]
    v_exp_f32_e64 v230, v230
    v_mfma_f32_16x16x32_bf16 v[112:115], v[168:171], v[32:35], v[136:139]
    v_exp_f32 v231, v231
    v_exp_f32 v232, v232
    v_exp_f32 v233, v233
    v_exp_f32 v234, v234
    v_exp_f32_e64 v235, v235
    buffer_load_dword v4, v1, s[32:35], 0 offen offset:0
    buffer_load_dword v5, v1, s[32:35], 0 offen offset:64
    global_load_dword v180, v2, s[10:11] offset:0
    global_load_dword v181, v2, s[10:11] offset:128
    global_load_dword v182, v2, s[10:11] offset:256
    global_load_dword v183, v2, s[10:11] offset:384
    global_load_dword v184, v2, s[10:11] offset:512
    global_load_dword v185, v2, s[10:11] offset:640
    global_load_dword v186, v2, s[10:11] offset:768
    global_load_dword v187, v2, s[10:11] offset:896
    global_load_dword v196, v2, s[10:11] offset:2048
    global_load_dword v197, v2, s[10:11] offset:2176
    global_load_dword v198, v2, s[10:11] offset:2304
    global_load_dword v199, v2, s[10:11] offset:2432
    global_load_dword v200, v2, s[10:11] offset:2560
    global_load_dword v201, v2, s[10:11] offset:2688
    global_load_dword v202, v2, s[10:11] offset:2816
    global_load_dword v203, v2, s[10:11] offset:2944
    v_pk_fma_f32 v[220:221], v[220:221], s[64:65], s[64:65]
    v_pk_fma_f32 v[222:223], v[222:223], s[64:65], s[64:65]
    v_pk_fma_f32 v[224:225], v[224:225], s[64:65], s[64:65]
    v_pk_fma_f32 v[226:227], v[226:227], s[64:65], s[64:65]
    v_pk_fma_f32 v[228:229], v[228:229], s[64:65], s[64:65]
    v_pk_fma_f32 v[230:231], v[230:231], s[64:65], s[64:65]
    v_pk_fma_f32 v[232:233], v[232:233], s[64:65], s[64:65]
    v_pk_fma_f32 v[234:235], v[234:235], s[64:65], s[64:65]
    v_rcp_f32 v220, v220
    v_rcp_f32 v221, v221
    v_rcp_f32 v222, v222
    v_rcp_f32 v223, v223
    v_rcp_f32 v224, v224
    v_rcp_f32 v225, v225
    v_rcp_f32 v226, v226
    v_rcp_f32 v227, v227
    v_rcp_f32 v228, v228
    v_rcp_f32 v229, v229
    v_rcp_f32 v230, v230
    v_rcp_f32 v231, v231
    v_rcp_f32 v232, v232
    v_rcp_f32 v233, v233
    v_rcp_f32 v234, v234
    v_rcp_f32 v235, v235
    v_pk_mul_f32 v[116:117], v[116:117], v[220:221]
    v_pk_mul_f32 v[118:119], v[118:119], v[222:223]
    v_pk_mul_f32 v[120:121], v[120:121], v[224:225]
    v_pk_mul_f32 v[122:123], v[122:123], v[226:227]
    v_pk_mul_f32 v[124:125], v[124:125], v[228:229]
    v_pk_mul_f32 v[126:127], v[126:127], v[230:231]
    v_pk_mul_f32 v[128:129], v[128:129], v[232:233]
    v_pk_mul_f32 v[130:131], v[130:131], v[234:235]
    v_pk_fma_f32 v[220:221], v[100:101], v[100:101], s[26:27]
    v_pk_fma_f32 v[222:223], v[102:103], v[102:103], s[26:27]
    v_pk_fma_f32 v[224:225], v[104:105], v[104:105], s[26:27]
    v_pk_fma_f32 v[226:227], v[106:107], v[106:107], s[26:27]
    v_pk_fma_f32 v[228:229], v[108:109], v[108:109], s[26:27]
    v_pk_fma_f32 v[230:231], v[110:111], v[110:111], s[26:27]
    v_pk_fma_f32 v[232:233], v[112:113], v[112:113], s[26:27]
    v_pk_fma_f32 v[234:235], v[114:115], v[114:115], s[26:27]
    v_pk_mul_f32 v[220:221], v[220:221], v[100:101] neg_lo:[0,1] neg_hi:[0,1]
    v_pk_mul_f32 v[222:223], v[222:223], v[102:103] neg_lo:[0,1] neg_hi:[0,1]
    v_pk_mul_f32 v[224:225], v[224:225], v[104:105] neg_lo:[0,1] neg_hi:[0,1]
    v_pk_mul_f32 v[226:227], v[226:227], v[106:107] neg_lo:[0,1] neg_hi:[0,1]
    v_pk_mul_f32 v[228:229], v[228:229], v[108:109] neg_lo:[0,1] neg_hi:[0,1]
    v_pk_mul_f32 v[230:231], v[230:231], v[110:111] neg_lo:[0,1] neg_hi:[0,1]
    v_pk_mul_f32 v[232:233], v[232:233], v[112:113] neg_lo:[0,1] neg_hi:[0,1]
    v_pk_mul_f32 v[234:235], v[234:235], v[114:115] neg_lo:[0,1] neg_hi:[0,1]
    v_smfmac_f32_16x16x64_bf16 v[68:71], v[188:191], v[116:123], v7
    v_exp_f32_e64 v220, v220
    v_smfmac_f32_16x16x64_bf16 v[72:75], v[192:195], v[116:123], v7
    v_exp_f32_e64 v221, v221
    v_smfmac_f32_16x16x64_bf16 v[76:79], v[188:191], v[124:131], v7
    v_exp_f32_e64 v222, v222
    v_smfmac_f32_16x16x64_bf16 v[80:83], v[192:195], v[124:131], v7
    v_exp_f32_e64 v223, v223
    v_mfma_f32_16x16x32_bf16 v[116:119], v[164:167], v[36:39], v[132:135]
    v_exp_f32_e64 v224, v224
    v_mfma_f32_16x16x32_bf16 v[120:123], v[168:171], v[36:39], v[136:139]
    v_exp_f32_e64 v225, v225
    v_mfma_f32_16x16x32_bf16 v[124:127], v[164:167], v[40:43], v[132:135]
    v_exp_f32_e64 v226, v226
    v_mfma_f32_16x16x32_bf16 v[128:131], v[168:171], v[40:43], v[136:139]
    v_exp_f32 v227, v227
    v_exp_f32 v228, v228
    v_exp_f32 v229, v229
    v_exp_f32 v230, v230
    v_exp_f32 v231, v231
    v_exp_f32 v232, v232
    v_exp_f32 v233, v233
    v_exp_f32 v234, v234
    v_exp_f32 v235, v235
    s_waitcnt vmcnt(16)
    v_perm_b32 v172, v149, v148, s30
    v_perm_b32 v173, v151, v150, s30
    v_perm_b32 v174, v153, v152, s30
    v_perm_b32 v175, v155, v154, s30
    v_perm_b32 v176, v149, v148, s31
    v_perm_b32 v177, v151, v150, s31
    v_perm_b32 v178, v153, v152, s31
    v_perm_b32 v179, v155, v154, s31
    s_getpc_b64 s[22:23]
    s_cmp_lg_u32 s3, 0
    s_cbranch_scc1 L_HANDLER
    v_pk_fma_f32 v[220:221], v[220:221], s[64:65], s[64:65]
    v_pk_fma_f32 v[222:223], v[222:223], s[64:65], s[64:65]
    v_pk_fma_f32 v[224:225], v[224:225], s[64:65], s[64:65]
    v_pk_fma_f32 v[226:227], v[226:227], s[64:65], s[64:65]
    v_pk_fma_f32 v[228:229], v[228:229], s[64:65], s[64:65]
    v_pk_fma_f32 v[230:231], v[230:231], s[64:65], s[64:65]
    v_pk_fma_f32 v[232:233], v[232:233], s[64:65], s[64:65]
    v_pk_fma_f32 v[234:235], v[234:235], s[64:65], s[64:65]
    v_rcp_f32 v220, v220
    v_rcp_f32 v221, v221
    v_rcp_f32 v222, v222
    v_rcp_f32 v223, v223
    v_rcp_f32 v224, v224
    v_rcp_f32 v225, v225
    v_rcp_f32 v226, v226
    v_rcp_f32 v227, v227
    v_rcp_f32 v228, v228
    v_rcp_f32 v229, v229
    v_rcp_f32 v230, v230
    v_rcp_f32 v231, v231
    v_rcp_f32 v232, v232
    v_rcp_f32 v233, v233
    v_rcp_f32 v234, v234
    v_rcp_f32_e64 v235, v235
    v_pk_mul_f32 v[100:101], v[100:101], v[220:221]
    v_pk_mul_f32 v[102:103], v[102:103], v[222:223]
    v_pk_mul_f32 v[104:105], v[104:105], v[224:225]
    v_pk_mul_f32 v[106:107], v[106:107], v[226:227]
    v_pk_mul_f32 v[108:109], v[108:109], v[228:229]
    v_pk_mul_f32 v[110:111], v[110:111], v[230:231]
    v_pk_mul_f32 v[112:113], v[112:113], v[232:233]
    v_pk_mul_f32 v[114:115], v[114:115], v[234:235]
    v_pk_fma_f32 v[220:221], v[116:117], v[116:117], s[26:27]
    v_pk_fma_f32 v[222:223], v[118:119], v[118:119], s[26:27]
    v_pk_fma_f32 v[224:225], v[120:121], v[120:121], s[26:27]
    v_pk_fma_f32 v[226:227], v[122:123], v[122:123], s[26:27]
    v_pk_fma_f32 v[228:229], v[124:125], v[124:125], s[26:27]
    v_pk_fma_f32 v[230:231], v[126:127], v[126:127], s[26:27]
    v_pk_fma_f32 v[232:233], v[128:129], v[128:129], s[26:27]
    v_pk_fma_f32 v[234:235], v[130:131], v[130:131], s[26:27]
    v_pk_mul_f32 v[220:221], v[220:221], v[116:117] neg_lo:[0,1] neg_hi:[0,1]
    v_pk_mul_f32 v[222:223], v[222:223], v[118:119] neg_lo:[0,1] neg_hi:[0,1]
    v_pk_mul_f32 v[224:225], v[224:225], v[120:121] neg_lo:[0,1] neg_hi:[0,1]
    v_pk_mul_f32 v[226:227], v[226:227], v[122:123] neg_lo:[0,1] neg_hi:[0,1]
    v_pk_mul_f32 v[228:229], v[228:229], v[124:125] neg_lo:[0,1] neg_hi:[0,1]
    v_pk_mul_f32 v[230:231], v[230:231], v[126:127] neg_lo:[0,1] neg_hi:[0,1]
    v_pk_mul_f32 v[232:233], v[232:233], v[128:129] neg_lo:[0,1] neg_hi:[0,1]
    v_pk_mul_f32 v[234:235], v[234:235], v[130:131] neg_lo:[0,1] neg_hi:[0,1]
    v_mfma_f32_16x16x16_bf16 v[132:135], v[4:5], v[204:205], 0
    v_exp_f32 v220, v220
    v_exp_f32 v221, v221
    v_mfma_f32_16x16x16_bf16 v[136:139], v[4:5], v[208:209], 0
    v_exp_f32 v222, v222
    v_exp_f32 v223, v223
    v_smfmac_f32_16x16x64_bf16 v[52:55], v[212:215], v[100:107], v7
    v_exp_f32_e64 v224, v224
    v_smfmac_f32_16x16x64_bf16 v[56:59], v[216:219], v[100:107], v7
    v_exp_f32_e64 v225, v225
    v_smfmac_f32_16x16x64_bf16 v[60:63], v[212:215], v[108:115], v7
    v_exp_f32_e64 v226, v226
    v_smfmac_f32_16x16x64_bf16 v[64:67], v[216:219], v[108:115], v7
    v_exp_f32_e64 v227, v227
    v_mfma_f32_16x16x32_bf16 v[100:103], v[172:175], v[28:31], v[132:135]
    v_exp_f32_e64 v228, v228
    v_mfma_f32_16x16x32_bf16 v[104:107], v[176:179], v[28:31], v[136:139]
    v_exp_f32_e64 v229, v229
    v_mfma_f32_16x16x32_bf16 v[108:111], v[172:175], v[32:35], v[132:135]
    v_exp_f32_e64 v230, v230
    v_mfma_f32_16x16x32_bf16 v[112:115], v[176:179], v[32:35], v[136:139]
    v_exp_f32 v231, v231
    v_exp_f32 v232, v232
    v_exp_f32 v233, v233
    v_exp_f32 v234, v234
    v_exp_f32 v235, v235
    s_nop 0
    v_pk_fma_f32 v[220:221], v[220:221], s[64:65], s[64:65]
    v_pk_fma_f32 v[222:223], v[222:223], s[64:65], s[64:65]
    v_pk_fma_f32 v[224:225], v[224:225], s[64:65], s[64:65]
    v_pk_fma_f32 v[226:227], v[226:227], s[64:65], s[64:65]
    v_pk_fma_f32 v[228:229], v[228:229], s[64:65], s[64:65]
    v_pk_fma_f32 v[230:231], v[230:231], s[64:65], s[64:65]
    v_pk_fma_f32 v[232:233], v[232:233], s[64:65], s[64:65]
    v_pk_fma_f32 v[234:235], v[234:235], s[64:65], s[64:65]
    v_rcp_f32 v220, v220
    v_rcp_f32 v221, v221
    v_rcp_f32 v222, v222
    v_rcp_f32 v223, v223
    v_rcp_f32 v224, v224
    v_rcp_f32 v225, v225
    v_rcp_f32 v226, v226
    v_rcp_f32 v227, v227
    v_rcp_f32 v228, v228
    v_rcp_f32 v229, v229
    v_rcp_f32 v230, v230
    v_rcp_f32 v231, v231
    v_rcp_f32 v232, v232
    v_rcp_f32 v233, v233
    v_rcp_f32 v234, v234
    v_rcp_f32 v235, v235
    v_pk_mul_f32 v[116:117], v[116:117], v[220:221]
    v_pk_mul_f32 v[118:119], v[118:119], v[222:223]
    v_pk_mul_f32 v[120:121], v[120:121], v[224:225]
    v_pk_mul_f32 v[122:123], v[122:123], v[226:227]
    v_pk_mul_f32 v[124:125], v[124:125], v[228:229]
    v_pk_mul_f32 v[126:127], v[126:127], v[230:231]
    v_pk_mul_f32 v[128:129], v[128:129], v[232:233]
    v_pk_mul_f32 v[130:131], v[130:131], v[234:235]
    s_add_u32 s24, s24, 4
    s_cmp_lt_u32 s24, 72
    s_cbranch_scc1 L_V22
    s_bitcmp1_b32 s44, 1
    s_cbranch_scc1 L_DVb
L_DVa:
    ds_read_b32 v15, v6 offset:4
    v_add_u32 v146, s1, v145
    s_bitcmp1_b32 s44, 0
    s_cselect_b32 s80, 0, 16
    v_lshlrev_b32 v24, s80, v20
    v_and_b32 v24, 0xffff0000, v24
    v_pk_fma_f32 v[220:221], v[100:101], v[100:101], s[26:27]
    v_pk_fma_f32 v[222:223], v[102:103], v[102:103], s[26:27]
    v_pk_fma_f32 v[224:225], v[104:105], v[104:105], s[26:27]
    v_pk_fma_f32 v[226:227], v[106:107], v[106:107], s[26:27]
    v_pk_fma_f32 v[228:229], v[108:109], v[108:109], s[26:27]
    v_pk_fma_f32 v[230:231], v[110:111], v[110:111], s[26:27]
    v_pk_fma_f32 v[232:233], v[112:113], v[112:113], s[26:27]
    v_pk_fma_f32 v[234:235], v[114:115], v[114:115], s[26:27]
    v_pk_mul_f32 v[220:221], v[220:221], v[100:101] neg_lo:[0,1] neg_hi:[0,1]
    v_pk_mul_f32 v[222:223], v[222:223], v[102:103] neg_lo:[0,1] neg_hi:[0,1]
    v_pk_mul_f32 v[224:225], v[224:225], v[104:105] neg_lo:[0,1] neg_hi:[0,1]
    v_pk_mul_f32 v[226:227], v[226:227], v[106:107] neg_lo:[0,1] neg_hi:[0,1]
    v_pk_mul_f32 v[228:229], v[228:229], v[108:109] neg_lo:[0,1] neg_hi:[0,1]
    v_pk_mul_f32 v[230:231], v[230:231], v[110:111] neg_lo:[0,1] neg_hi:[0,1]
    v_pk_mul_f32 v[232:233], v[232:233], v[112:113] neg_lo:[0,1] neg_hi:[0,1]
    v_pk_mul_f32 v[234:235], v[234:235], v[114:115] neg_lo:[0,1] neg_hi:[0,1]
    v_smfmac_f32_16x16x64_bf16 v[68:71], v[212:215], v[116:123], v7
    v_exp_f32_e64 v220, v220
    v_smfmac_f32_16x16x64_bf16 v[72:75], v[216:219], v[116:123], v7
    v_exp_f32_e64 v221, v221
    v_smfmac_f32_16x16x64_bf16 v[76:79], v[212:215], v[124:131], v7
    v_exp_f32_e64 v222, v222
    v_smfmac_f32_16x16x64_bf16 v[80:83], v[216:219], v[124:131], v7
    v_exp_f32 v223, v223
    v_exp_f32 v224, v224
    v_exp_f32 v225, v225
    v_exp_f32 v226, v226
    v_exp_f32 v227, v227
    v_exp_f32 v228, v228
    v_exp_f32 v229, v229
    v_exp_f32 v230, v230
    v_exp_f32 v231, v231
    v_exp_f32 v232, v232
    v_exp_f32 v233, v233
    v_exp_f32 v234, v234
    v_exp_f32 v235, v235
    s_waitcnt vmcnt(8)
    v_perm_b32 v188, v181, v180, s30
    v_perm_b32 v189, v183, v182, s30
    v_perm_b32 v190, v185, v184, s30
    v_perm_b32 v191, v187, v186, s30
    v_perm_b32 v192, v181, v180, s31
    v_perm_b32 v193, v183, v182, s31
    v_perm_b32 v194, v185, v184, s31
    v_perm_b32 v195, v187, v186, s31
    s_waitcnt lgkmcnt(0)
    v_readfirstlane_b32 s80, v15
L_spinDVa:
    s_lshl_b32 m0, s44, 10
    s_nop 2
    s_cmp_lg_u32 s80, 6
    s_cbranch_scc1 L_respinDVa
    ds_write_addtid_b32 v68 offset:0
    ds_write_addtid_b32 v69 offset:256
    ds_write_addtid_b32 v70 offset:512
    ds_write_addtid_b32 v71 offset:768
    ds_write_addtid_b32 v72 offset:8192
    ds_write_addtid_b32 v73 offset:8448
    ds_write_addtid_b32 v74 offset:8704
    ds_write_addtid_b32 v75 offset:8960
    ds_write_addtid_b32 v76 offset:16384
    ds_write_addtid_b32 v77 offset:16640
    ds_write_addtid_b32 v78 offset:16896
    ds_write_addtid_b32 v79 offset:17152
    ds_write_addtid_b32 v80 offset:24576
    ds_write_addtid_b32 v81 offset:24832
    ds_write_addtid_b32 v82 offset:25088
    ds_write_addtid_b32 v83 offset:25344
    v_pk_fma_f32 v[220:221], v[220:221], s[64:65], s[64:65]
    v_pk_fma_f32 v[222:223], v[222:223], s[64:65], s[64:65]
    v_pk_fma_f32 v[224:225], v[224:225], s[64:65], s[64:65]
    v_pk_fma_f32 v[226:227], v[226:227], s[64:65], s[64:65]
    v_pk_fma_f32 v[228:229], v[228:229], s[64:65], s[64:65]
    v_pk_fma_f32 v[230:231], v[230:231], s[64:65], s[64:65]
    v_pk_fma_f32 v[232:233], v[232:233], s[64:65], s[64:65]
    v_pk_fma_f32 v[234:235], v[234:235], s[64:65], s[64:65]
    v_rcp_f32 v220, v220
    v_rcp_f32 v221, v221
    v_rcp_f32 v222, v222
    v_rcp_f32 v223, v223
    v_rcp_f32 v224, v224
    v_rcp_f32 v225, v225
    v_rcp_f32 v226, v226
    v_rcp_f32 v227, v227
    v_rcp_f32 v228, v228
    v_rcp_f32 v229, v229
    v_rcp_f32 v230, v230
    v_rcp_f32 v231, v231
    v_rcp_f32 v232, v232
    v_rcp_f32 v233, v233
    v_rcp_f32 v234, v234
    v_rcp_f32 v235, v235
    v_pk_mul_f32 v[100:101], v[100:101], v[220:221]
    v_pk_mul_f32 v[102:103], v[102:103], v[222:223]
    v_pk_mul_f32 v[104:105], v[104:105], v[224:225]
    v_pk_mul_f32 v[106:107], v[106:107], v[226:227]
    v_pk_mul_f32 v[108:109], v[108:109], v[228:229]
    v_pk_mul_f32 v[110:111], v[110:111], v[230:231]
    v_pk_mul_f32 v[112:113], v[112:113], v[232:233]
    v_pk_mul_f32 v[114:115], v[114:115], v[234:235]
    s_setprio 3
    s_nop 0
    v_smfmac_f32_16x16x64_bf16 v[52:55], v[188:191], v[100:107], v7
    v_smfmac_f32_16x16x64_bf16 v[56:59], v[192:195], v[100:107], v7
    v_smfmac_f32_16x16x64_bf16 v[60:63], v[188:191], v[108:115], v7
    v_smfmac_f32_16x16x64_bf16 v[64:67], v[192:195], v[108:115], v7
    s_nop 4
    s_nop 0
    ds_write_addtid_b32 v52 offset:32768
    ds_write_addtid_b32 v53 offset:33024
    ds_write_addtid_b32 v54 offset:33280
    ds_write_addtid_b32 v55 offset:33536
    ds_write_addtid_b32 v56 offset:40960
    ds_write_addtid_b32 v57 offset:41216
    ds_write_addtid_b32 v58 offset:41472
    ds_write_addtid_b32 v59 offset:41728
    ds_write_addtid_b32 v60 offset:49152
    ds_write_addtid_b32 v61 offset:49408
    ds_write_addtid_b32 v62 offset:49664
    ds_write_addtid_b32 v63 offset:49920
    ds_write_addtid_b32 v64 offset:57344
    ds_write_addtid_b32 v65 offset:57600
    ds_write_addtid_b32 v66 offset:57856
    ds_write_addtid_b32 v67 offset:58112
    s_branch L_EPI
L_DVb:
    v_add_u32 v146, s1, v145
    s_bitcmp1_b32 s44, 0
    s_cselect_b32 s80, 0, 16
    v_lshlrev_b32_e64 v24, s80, v20
    v_and_b32 v24, 0xffff0000, v24
    v_perm_b32 v164, v157, v156, s30
    v_perm_b32 v165, v159, v158, s30
    v_perm_b32 v166, v161, v160, s30
    v_perm_b32 v167, v163, v162, s30
    v_perm_b32 v168, v157, v156, s31
    v_perm_b32 v169, v159, v158, s31
    v_perm_b32 v170, v161, v160, s31
    v_perm_b32 v171, v163, v162, s31
    v_pk_fma_f32 v[220:221], v[100:101], v[100:101], s[26:27]
    v_pk_fma_f32 v[222:223], v[102:103], v[102:103], s[26:27]
    v_pk_fma_f32 v[224:225], v[104:105], v[104:105], s[26:27]
    v_pk_fma_f32 v[226:227], v[106:107], v[106:107], s[26:27]
    v_pk_fma_f32 v[228:229], v[108:109], v[108:109], s[26:27]
    v_pk_fma_f32 v[230:231], v[110:111], v[110:111], s[26:27]
    v_pk_fma_f32 v[232:233], v[112:113], v[112:113], s[26:27]
    v_pk_fma_f32 v[234:235], v[114:115], v[114:115], s[26:27]
    v_pk_mul_f32 v[220:221], v[220:221], v[100:101] neg_lo:[0,1] neg_hi:[0,1]
    v_pk_mul_f32 v[222:223], v[222:223], v[102:103] neg_lo:[0,1] neg_hi:[0,1]
    v_pk_mul_f32 v[224:225], v[224:225], v[104:105] neg_lo:[0,1] neg_hi:[0,1]
    v_pk_mul_f32 v[226:227], v[226:227], v[106:107] neg_lo:[0,1] neg_hi:[0,1]
    v_pk_mul_f32 v[228:229], v[228:229], v[108:109] neg_lo:[0,1] neg_hi:[0,1]
    v_pk_mul_f32 v[230:231], v[230:231], v[110:111] neg_lo:[0,1] neg_hi:[0,1]
    v_pk_mul_f32 v[232:233], v[232:233], v[112:113] neg_lo:[0,1] neg_hi:[0,1]
    v_pk_mul_f32 v[234:235], v[234:235], v[114:115] neg_lo:[0,1] neg_hi:[0,1]
    v_smfmac_f32_16x16x64_bf16 v[68:71], v[212:215], v[116:123], v7
    v_exp_f32_e64 v220, v220
    v_smfmac_f32_16x16x64_bf16 v[72:75], v[216:219], v[116:123], v7
    v_exp_f32_e64 v221, v221
    v_smfmac_f32_16x16x64_bf16 v[76:79], v[212:215], v[124:131], v7
    v_exp_f32_e64 v222, v222
    v_smfmac_f32_16x16x64_bf16 v[80:83], v[216:219], v[124:131], v7
    v_exp_f32_e64 v223, v223
    v_mfma_f32_16x16x32_bf16 v[116:119], v[172:175], v[36:39], v[132:135]
    v_exp_f32_e64 v224, v224
    v_mfma_f32_16x16x32_bf16 v[120:123], v[176:179], v[36:39], v[136:139]
    v_exp_f32_e64 v225, v225
    v_mfma_f32_16x16x32_bf16 v[124:127], v[172:175], v[40:43], v[132:135]
    v_exp_f32_e64 v226, v226
    v_mfma_f32_16x16x32_bf16 v[128:131], v[176:179], v[40:43], v[136:139]
    v_exp_f32 v227, v227
    v_exp_f32 v228, v228
    v_exp_f32 v229, v229
    v_exp_f32 v230, v230
    v_exp_f32 v231, v231
    v_exp_f32 v232, v232
    v_exp_f32 v233, v233
    v_exp_f32 v234, v234
    v_exp_f32 v235, v235
    s_waitcnt vmcnt(0)
    v_perm_b32 v188, v181, v180, s30
    v_perm_b32 v189, v183, v182, s30
    v_perm_b32 v190, v185, v184, s30
    v_perm_b32 v191, v187, v186, s30
    v_perm_b32 v192, v181, v180, s31
    v_perm_b32 v193, v183, v182, s31
    v_perm_b32 v194, v185, v184, s31
    v_perm_b32 v195, v187, v186, s31
    v_perm_b32 v212, v197, v196, s30
    v_perm_b32 v213, v199, v198, s30
    v_perm_b32 v214, v201, v200, s30
    v_perm_b32 v215, v203, v202, s30
    v_perm_b32 v216, v197, v196, s31
    v_perm_b32 v217, v199, v198, s31
    v_perm_b32 v218, v201, v200, s31
    v_perm_b32 v219, v203, v202, s31
    s_getpc_b64 s[22:23]
    s_cmp_lg_u32 s3, 0
    s_cbranch_scc1 L_HANDLER
    v_pk_fma_f32 v[220:221], v[220:221], s[64:65], s[64:65]
    v_pk_fma_f32 v[222:223], v[222:223], s[64:65], s[64:65]
    v_pk_fma_f32 v[224:225], v[224:225], s[64:65], s[64:65]
    v_pk_fma_f32 v[226:227], v[226:227], s[64:65], s[64:65]
    v_pk_fma_f32 v[228:229], v[228:229], s[64:65], s[64:65]
    v_pk_fma_f32 v[230:231], v[230:231], s[64:65], s[64:65]
    v_pk_fma_f32 v[232:233], v[232:233], s[64:65], s[64:65]
    v_pk_fma_f32 v[234:235], v[234:235], s[64:65], s[64:65]
    v_rcp_f32 v220, v220
    v_rcp_f32 v221, v221
    v_rcp_f32 v222, v222
    v_rcp_f32 v223, v223
    v_rcp_f32 v224, v224
    v_rcp_f32 v225, v225
    v_rcp_f32 v226, v226
    v_rcp_f32 v227, v227
    v_rcp_f32 v228, v228
    v_rcp_f32 v229, v229
    v_rcp_f32 v230, v230
    v_rcp_f32 v231, v231
    v_rcp_f32 v232, v232
    v_rcp_f32 v233, v233
    v_rcp_f32 v234, v234
    v_rcp_f32_e64 v235, v235
    v_pk_mul_f32 v[100:101], v[100:101], v[220:221]
    v_pk_mul_f32 v[102:103], v[102:103], v[222:223]
    v_pk_mul_f32 v[104:105], v[104:105], v[224:225]
    v_pk_mul_f32 v[106:107], v[106:107], v[226:227]
    v_pk_mul_f32 v[108:109], v[108:109], v[228:229]
    v_pk_mul_f32 v[110:111], v[110:111], v[230:231]
    v_pk_mul_f32 v[112:113], v[112:113], v[232:233]
    v_pk_mul_f32 v[114:115], v[114:115], v[234:235]
    v_pk_fma_f32 v[220:221], v[116:117], v[116:117], s[26:27]
    v_pk_fma_f32 v[222:223], v[118:119], v[118:119], s[26:27]
    v_pk_fma_f32 v[224:225], v[120:121], v[120:121], s[26:27]
    v_pk_fma_f32 v[226:227], v[122:123], v[122:123], s[26:27]
    v_pk_fma_f32 v[228:229], v[124:125], v[124:125], s[26:27]
    v_pk_fma_f32 v[230:231], v[126:127], v[126:127], s[26:27]
    v_pk_fma_f32 v[232:233], v[128:129], v[128:129], s[26:27]
    v_pk_fma_f32 v[234:235], v[130:131], v[130:131], s[26:27]
    v_pk_mul_f32 v[220:221], v[220:221], v[116:117] neg_lo:[0,1] neg_hi:[0,1]
    v_pk_mul_f32 v[222:223], v[222:223], v[118:119] neg_lo:[0,1] neg_hi:[0,1]
    v_pk_mul_f32 v[224:225], v[224:225], v[120:121] neg_lo:[0,1] neg_hi:[0,1]
    v_pk_mul_f32 v[226:227], v[226:227], v[122:123] neg_lo:[0,1] neg_hi:[0,1]
    v_pk_mul_f32 v[228:229], v[228:229], v[124:125] neg_lo:[0,1] neg_hi:[0,1]
    v_pk_mul_f32 v[230:231], v[230:231], v[126:127] neg_lo:[0,1] neg_hi:[0,1]
    v_pk_mul_f32 v[232:233], v[232:233], v[128:129] neg_lo:[0,1] neg_hi:[0,1]
    v_pk_mul_f32 v[234:235], v[234:235], v[130:131] neg_lo:[0,1] neg_hi:[0,1]
    v_mfma_f32_16x16x16_bf16 v[132:135], v[4:5], v[206:207], 0
    v_exp_f32 v220, v220
    v_exp_f32 v221, v221
    v_mfma_f32_16x16x16_bf16 v[136:139], v[4:5], v[210:211], 0
    v_exp_f32 v222, v222
    v_exp_f32 v223, v223
    v_smfmac_f32_16x16x64_bf16 v[52:55], v[188:191], v[100:107], v7
    v_exp_f32_e64 v224, v224
    v_smfmac_f32_16x16x64_bf16 v[56:59], v[192:195], v[100:107], v7
    v_exp_f32_e64 v225, v225
    v_smfmac_f32_16x16x64_bf16 v[60:63], v[188:191], v[108:115], v7
    v_exp_f32_e64 v226, v226
    v_smfmac_f32_16x16x64_bf16 v[64:67], v[192:195], v[108:115], v7
    v_exp_f32_e64 v227, v227
    v_mfma_f32_16x16x32_bf16 v[100:103], v[164:167], v[36:39], v[132:135]
    v_exp_f32_e64 v228, v228
    v_mfma_f32_16x16x32_bf16 v[104:107], v[168:171], v[36:39], v[136:139]
    v_exp_f32_e64 v229, v229
    v_mfma_f32_16x16x32_bf16 v[108:111], v[164:167], v[40:43], v[132:135]
    v_exp_f32_e64 v230, v230
    v_mfma_f32_16x16x32_bf16 v[112:115], v[168:171], v[40:43], v[136:139]
    v_exp_f32 v231, v231
    v_exp_f32 v232, v232
    v_exp_f32 v233, v233
    v_exp_f32 v234, v234
    v_exp_f32 v235, v235
    s_nop 0
    v_pk_fma_f32 v[220:221], v[220:221], s[64:65], s[64:65]
    v_pk_fma_f32 v[222:223], v[222:223], s[64:65], s[64:65]
    v_pk_fma_f32 v[224:225], v[224:225], s[64:65], s[64:65]
    v_pk_fma_f32 v[226:227], v[226:227], s[64:65], s[64:65]
    v_pk_fma_f32 v[228:229], v[228:229], s[64:65], s[64:65]
    v_pk_fma_f32 v[230:231], v[230:231], s[64:65], s[64:65]
    v_pk_fma_f32 v[232:233], v[232:233], s[64:65], s[64:65]
    v_pk_fma_f32 v[234:235], v[234:235], s[64:65], s[64:65]
    v_rcp_f32 v220, v220
    v_rcp_f32 v221, v221
    v_rcp_f32 v222, v222
    v_rcp_f32 v223, v223
    v_rcp_f32 v224, v224
    v_rcp_f32 v225, v225
    v_rcp_f32 v226, v226
    v_rcp_f32 v227, v227
    v_rcp_f32 v228, v228
    v_rcp_f32 v229, v229
    v_rcp_f32 v230, v230
    v_rcp_f32 v231, v231
    v_rcp_f32 v232, v232
    v_rcp_f32 v233, v233
    v_rcp_f32 v234, v234
    v_rcp_f32 v235, v235
    v_pk_mul_f32 v[116:117], v[116:117], v[220:221]
    v_pk_mul_f32 v[118:119], v[118:119], v[222:223]
    v_pk_mul_f32 v[120:121], v[120:121], v[224:225]
    v_pk_mul_f32 v[122:123], v[122:123], v[226:227]
    v_pk_mul_f32 v[124:125], v[124:125], v[228:229]
    v_pk_mul_f32 v[126:127], v[126:127], v[230:231]
    v_pk_mul_f32 v[128:129], v[128:129], v[232:233]
    v_pk_mul_f32 v[130:131], v[130:131], v[234:235]
    v_pk_fma_f32 v[220:221], v[100:101], v[100:101], s[26:27]
    v_pk_fma_f32 v[222:223], v[102:103], v[102:103], s[26:27]
    v_pk_fma_f32 v[224:225], v[104:105], v[104:105], s[26:27]
    v_pk_fma_f32 v[226:227], v[106:107], v[106:107], s[26:27]
    v_pk_fma_f32 v[228:229], v[108:109], v[108:109], s[26:27]
    v_pk_fma_f32 v[230:231], v[110:111], v[110:111], s[26:27]
    v_pk_fma_f32 v[232:233], v[112:113], v[112:113], s[26:27]
    v_pk_fma_f32 v[234:235], v[114:115], v[114:115], s[26:27]
    v_pk_mul_f32 v[220:221], v[220:221], v[100:101] neg_lo:[0,1] neg_hi:[0,1]
    v_pk_mul_f32 v[222:223], v[222:223], v[102:103] neg_lo:[0,1] neg_hi:[0,1]
    v_pk_mul_f32 v[224:225], v[224:225], v[104:105] neg_lo:[0,1] neg_hi:[0,1]
    v_pk_mul_f32 v[226:227], v[226:227], v[106:107] neg_lo:[0,1] neg_hi:[0,1]
    v_pk_mul_f32 v[228:229], v[228:229], v[108:109] neg_lo:[0,1] neg_hi:[0,1]
    v_pk_mul_f32 v[230:231], v[230:231], v[110:111] neg_lo:[0,1] neg_hi:[0,1]
    v_pk_mul_f32 v[232:233], v[232:233], v[112:113] neg_lo:[0,1] neg_hi:[0,1]
    v_pk_mul_f32 v[234:235], v[234:235], v[114:115] neg_lo:[0,1] neg_hi:[0,1]
    v_smfmac_f32_16x16x64_bf16 v[68:71], v[188:191], v[116:123], v7
    v_exp_f32_e64 v220, v220
    v_smfmac_f32_16x16x64_bf16 v[72:75], v[192:195], v[116:123], v7
    v_exp_f32_e64 v221, v221
    v_smfmac_f32_16x16x64_bf16 v[76:79], v[188:191], v[124:131], v7
    v_exp_f32_e64 v222, v222
    v_smfmac_f32_16x16x64_bf16 v[80:83], v[192:195], v[124:131], v7
    v_exp_f32_e64 v223, v223
    v_mfma_f32_16x16x32_bf16 v[116:119], v[164:167], v[28:31], v[132:135]
    v_exp_f32_e64 v224, v224
    v_mfma_f32_16x16x32_bf16 v[120:123], v[168:171], v[28:31], v[136:139]
    v_exp_f32_e64 v225, v225
    v_mfma_f32_16x16x32_bf16 v[124:127], v[164:167], v[32:35], v[132:135]
    v_exp_f32_e64 v226, v226
    v_mfma_f32_16x16x32_bf16 v[128:131], v[168:171], v[32:35], v[136:139]
    v_exp_f32 v227, v227
    v_exp_f32 v228, v228
    v_exp_f32 v229, v229
    v_exp_f32 v230, v230
    v_exp_f32 v231, v231
    v_exp_f32 v232, v232
    v_exp_f32 v233, v233
    v_exp_f32 v234, v234
    v_exp_f32_e64 v235, v235
    s_getpc_b64 s[22:23]
    s_cmp_lg_u32 s3, 0
    s_cbranch_scc1 L_HANDLER
    s_nop 0
    v_pk_fma_f32 v[220:221], v[220:221], s[64:65], s[64:65]
    v_pk_fma_f32 v[222:223], v[222:223], s[64:65], s[64:65]
    v_pk_fma_f32 v[224:225], v[224:225], s[64:65], s[64:65]
    v_pk_fma_f32 v[226:227], v[226:227], s[64:65], s[64:65]
    v_pk_fma_f32 v[228:229], v[228:229], s[64:65], s[64:65]
    v_pk_fma_f32 v[230:231], v[230:231], s[64:65], s[64:65]
    v_pk_fma_f32 v[232:233], v[232:233], s[64:65], s[64:65]
    v_pk_fma_f32 v[234:235], v[234:235], s[64:65], s[64:65]
    v_rcp_f32 v220, v220
    v_rcp_f32 v221, v221
    v_rcp_f32 v222, v222
    v_rcp_f32 v223, v223
    v_rcp_f32 v224, v224
    v_rcp_f32 v225, v225
    v_rcp_f32 v226, v226
    v_rcp_f32 v227, v227
    v_rcp_f32 v228, v228
    v_rcp_f32 v229, v229
    v_rcp_f32 v230, v230
    v_rcp_f32 v231, v231
    v_rcp_f32 v232, v232
    v_rcp_f32 v233, v233
    v_rcp_f32 v234, v234
    v_rcp_f32 v235, v235
    v_pk_mul_f32 v[100:101], v[100:101], v[220:221]
    v_pk_mul_f32 v[102:103], v[102:103], v[222:223]
    v_pk_mul_f32 v[104:105], v[104:105], v[224:225]
    v_pk_mul_f32 v[106:107], v[106:107], v[226:227]
    v_pk_mul_f32 v[108:109], v[108:109], v[228:229]
    v_pk_mul_f32 v[110:111], v[110:111], v[230:231]
    v_pk_mul_f32 v[112:113], v[112:113], v[232:233]
    v_pk_mul_f32 v[114:115], v[114:115], v[234:235]
    v_pk_fma_f32 v[220:221], v[116:117], v[116:117], s[26:27]
    v_pk_fma_f32 v[222:223], v[118:119], v[118:119], s[26:27]
    v_pk_fma_f32 v[224:225], v[120:121], v[120:121], s[26:27]
    v_pk_fma_f32 v[226:227], v[122:123], v[122:123], s[26:27]
    v_pk_fma_f32 v[228:229], v[124:125], v[124:125], s[26:27]
    v_pk_fma_f32 v[230:231], v[126:127], v[126:127], s[26:27]
    v_pk_fma_f32 v[232:233], v[128:129], v[128:129], s[26:27]
    v_pk_fma_f32 v[234:235], v[130:131], v[130:131], s[26:27]
    v_pk_mul_f32 v[220:221], v[220:221], v[116:117] neg_lo:[0,1] neg_hi:[0,1]
    v_pk_mul_f32 v[222:223], v[222:223], v[118:119] neg_lo:[0,1] neg_hi:[0,1]
    v_pk_mul_f32 v[224:225], v[224:225], v[120:121] neg_lo:[0,1] neg_hi:[0,1]
    v_pk_mul_f32 v[226:227], v[226:227], v[122:123] neg_lo:[0,1] neg_hi:[0,1]
    v_pk_mul_f32 v[228:229], v[228:229], v[124:125] neg_lo:[0,1] neg_hi:[0,1]
    v_pk_mul_f32 v[230:231], v[230:231], v[126:127] neg_lo:[0,1] neg_hi:[0,1]
    v_pk_mul_f32 v[232:233], v[232:233], v[128:129] neg_lo:[0,1] neg_hi:[0,1]
    v_pk_mul_f32 v[234:235], v[234:235], v[130:131] neg_lo:[0,1] neg_hi:[0,1]
    v_smfmac_f32_16x16x64_bf16 v[68:71], v[212:215], v[100:107], v7
    v_exp_f32_e64 v220, v220
    v_smfmac_f32_16x16x64_bf16 v[72:75], v[216:219], v[100:107], v7
    v_exp_f32_e64 v221, v221
    v_smfmac_f32_16x16x64_bf16 v[76:79], v[212:215], v[108:115], v7
    v_exp_f32_e64 v222, v222
    v_smfmac_f32_16x16x64_bf16 v[80:83], v[216:219], v[108:115], v7
    v_exp_f32 v223, v223
    v_exp_f32 v224, v224
    v_exp_f32 v225, v225
    v_exp_f32 v226, v226
    v_exp_f32 v227, v227
    v_exp_f32 v228, v228
    v_exp_f32 v229, v229
    v_exp_f32 v230, v230
    v_exp_f32 v231, v231
    v_exp_f32 v232, v232
    v_exp_f32 v233, v233
    v_exp_f32 v234, v234
    v_exp_f32 v235, v235
    s_nop 0
    v_pk_fma_f32 v[220:221], v[220:221], s[64:65], s[64:65]
    v_pk_fma_f32 v[222:223], v[222:223], s[64:65], s[64:65]
    v_pk_fma_f32 v[224:225], v[224:225], s[64:65], s[64:65]
    v_pk_fma_f32 v[226:227], v[226:227], s[64:65], s[64:65]
    v_pk_fma_f32 v[228:229], v[228:229], s[64:65], s[64:65]
    v_pk_fma_f32 v[230:231], v[230:231], s[64:65], s[64:65]
    v_pk_fma_f32 v[232:233], v[232:233], s[64:65], s[64:65]
    v_pk_fma_f32 v[234:235], v[234:235], s[64:65], s[64:65]
    v_rcp_f32 v220, v220
    v_rcp_f32 v221, v221
    v_rcp_f32 v222, v222
    v_rcp_f32 v223, v223
    v_rcp_f32 v224, v224
    v_rcp_f32 v225, v225
    v_rcp_f32 v226, v226
    v_rcp_f32 v227, v227
    v_rcp_f32 v228, v228
    v_rcp_f32 v229, v229
    v_rcp_f32 v230, v230
    v_rcp_f32 v231, v231
    v_rcp_f32 v232, v232
    v_rcp_f32 v233, v233
    v_rcp_f32 v234, v234
    v_rcp_f32 v235, v235
    v_pk_mul_f32 v[116:117], v[116:117], v[220:221]
    v_pk_mul_f32 v[118:119], v[118:119], v[222:223]
    v_pk_mul_f32 v[120:121], v[120:121], v[224:225]
    v_pk_mul_f32 v[122:123], v[122:123], v[226:227]
    v_pk_mul_f32 v[124:125], v[124:125], v[228:229]
    v_pk_mul_f32 v[126:127], v[126:127], v[230:231]
    v_pk_mul_f32 v[128:129], v[128:129], v[232:233]
    v_pk_mul_f32 v[130:131], v[130:131], v[234:235]
    s_setprio 3
    ds_read_b32 v15, v6 offset:4
    v_smfmac_f32_16x16x64_bf16 v[52:55], v[212:215], v[116:123], v7
    v_smfmac_f32_16x16x64_bf16 v[56:59], v[216:219], v[116:123], v7
    v_smfmac_f32_16x16x64_bf16 v[60:63], v[212:215], v[124:131], v7
    v_smfmac_f32_16x16x64_bf16 v[64:67], v[216:219], v[124:131], v7
    s_cmp_lg_u32 s3, 0
    s_cbranch_scc1 L_FIN
L_FIN2:
    s_waitcnt lgkmcnt(0)
    v_readfirstlane_b32 s80, v15
L_spinDVb:
    s_lshl_b32 m0, s44, 10
    s_nop 2
    s_cmp_lg_u32 s80, 6
    s_cbranch_scc1 L_respinDVb
    s_nop 0
    ds_write_addtid_b32 v68 offset:0
    ds_write_addtid_b32 v69 offset:256
    ds_write_addtid_b32 v70 offset:512
    ds_write_addtid_b32 v71 offset:768
    ds_write_addtid_b32 v72 offset:8192
    ds_write_addtid_b32 v73 offset:8448
    ds_write_addtid_b32 v74 offset:8704
    ds_write_addtid_b32 v75 offset:8960
    ds_write_addtid_b32 v76 offset:16384
    ds_write_addtid_b32 v77 offset:16640
    ds_write_addtid_b32 v78 offset:16896
    ds_write_addtid_b32 v79 offset:17152
    ds_write_addtid_b32 v80 offset:24576
    ds_write_addtid_b32 v81 offset:24832
    ds_write_addtid_b32 v82 offset:25088
    ds_write_addtid_b32 v83 offset:25344
    ds_write_addtid_b32 v52 offset:32768
    ds_write_addtid_b32 v53 offset:33024
    ds_write_addtid_b32 v54 offset:33280
    ds_write_addtid_b32 v55 offset:33536
    ds_write_addtid_b32 v56 offset:40960
    ds_write_addtid_b32 v57 offset:41216
    ds_write_addtid_b32 v58 offset:41472
    ds_write_addtid_b32 v59 offset:41728
    ds_write_addtid_b32 v60 offset:49152
    ds_write_addtid_b32 v61 offset:49408
    ds_write_addtid_b32 v62 offset:49664
    ds_write_addtid_b32 v63 offset:49920
    s_cmp_eq_u32 s44, 7
    s_cbranch_scc1 L_ew3DVb
    ds_write_addtid_b32 v64 offset:57344
    ds_write_addtid_b32 v65 offset:57600
    ds_write_addtid_b32 v66 offset:57856
    ds_write_addtid_b32 v67 offset:58112
L_ew3DVb:
L_EPI:
    s_cbranch_execz L_WARM2
    s_add_u32 s80, s44, 1
    s_and_b32 s80, s80, 6
    s_waitcnt lgkmcnt(0)
    s_barrier
    s_cbranch_scc0 L_OWN
L_OWN2:
    ds_read_b128 v[52:55], v11 offset:0
    ds_read_b128 v[56:59], v11 offset:1024
    ds_read_b128 v[60:63], v11 offset:2048
    ds_read_b128 v[64:67], v11 offset:3072
    ds_read_b128 v[68:71], v11 offset:4096
    ds_read_b128 v[72:75], v11 offset:5120
    ds_read_b128 v[76:79], v11 offset:6144
    ds_read_b128 v[80:83], v11 offset:7168
    s_waitcnt lgkmcnt(6)
    v_pk_add_f32 v[52:53], v[52:53], v[56:57]
    v_pk_add_f32 v[54:55], v[54:55], v[58:59]
    s_waitcnt lgkmcnt(4)
    v_pk_add_f32 v[60:61], v[60:61], v[64:65]
    v_pk_add_f32 v[62:63], v[62:63], v[66:67]
    v_pk_add_f32 v[52:53], v[52:53], v[60:61]
    v_pk_add_f32 v[54:55], v[54:55], v[62:63]
    s_waitcnt lgkmcnt(2)
    v_pk_add_f32 v[68:69], v[68:69], v[72:73]
    v_pk_add_f32 v[70:71], v[70:71], v[74:75]
    v_pk_add_f32 v[52:53], v[52:53], v[68:69]
    v_pk_add_f32 v[54:55], v[54:55], v[70:71]
    s_waitcnt lgkmcnt(0)
    v_pk_add_f32 v[76:77], v[76:77], v[80:81]
    v_pk_add_f32 v[78:79], v[78:79], v[82:83]
    v_pk_add_f32 v[52:53], v[52:53], v[76:77]
    v_pk_add_f32 v[54:55], v[54:55], v[78:79]
    v_pk_mul_f32 v[52:53], v[52:53], s[66:67]
    v_pk_mul_f32 v[54:55], v[54:55], s[66:67]
    v_cvt_pk_bf16_f32 v56, v52, v53
    v_cvt_pk_bf16_f32 v57, v54, v55
    v_lshlrev_b32_e64 v52, 16, v56
    v_and_b32 v53, 0xffff0000, v56
    v_lshlrev_b32_e64 v54, 16, v57
    v_and_b32 v55, 0xffff0000, v57
    v_pk_add_f32 v[52:53], v[52:53], v[24:25] op_sel_hi:[1,0]
    v_pk_add_f32 v[54:55], v[54:55], v[24:25] op_sel_hi:[1,0]
    v_cvt_pk_bf16_f32 v52, v52, v53
    v_cvt_pk_bf16_f32 v53, v54, v55
    buffer_store_dwordx2 v[52:53], v146, s[36:39], 0 offen offset:0
L_END:
    s_endpgm
L_OWN:
    s_cmp_eq_u32 s44, 0
    s_cbranch_scc0 L_OWN7
    ds_write_addtid_b32 v52 offset:0
    ds_write_addtid_b32 v53 offset:256
    ds_write_addtid_b32 v54 offset:512
    ds_write_addtid_b32 v55 offset:768
    s_branch L_OWN2
L_OWN7:
    ds_write_addtid_b32 v64 offset:57344
    ds_write_addtid_b32 v65 offset:57600
    ds_write_addtid_b32 v66 offset:57856
    ds_write_addtid_b32 v67 offset:58112
    s_branch L_OWN2
.section .rodata,"a"
.p2align 6
.amdhsa_kernel standalone__mixer_token_mlp__sampling_kernel
  .amdhsa_next_free_vgpr 256
  .amdhsa_next_free_sgpr 102
  .amdhsa_accum_offset 256
  .amdhsa_group_segment_fixed_size 0
  .amdhsa_kernarg_size 64
  .amdhsa_user_sgpr_count 2
  .amdhsa_user_sgpr_kernarg_segment_ptr 1
  .amdhsa_system_sgpr_workgroup_id_x 1
.end_amdhsa_kernel
```
